```python
import torch

def _softmax(x, axis=-1):
    return torch.softmax(x, dim=axis)
def _gelu(x):
    return torch.nn.functional.gelu(x, approximate="tanh")
def _silu(x):
    return torch.nn.functional.silu(x)
def _sigmoid(x):
    return torch.sigmoid(x)
def _layernorm(x, axis=-1, eps=1e-5):
    m = x.mean(dim=axis, keepdim=True)
    v = x.var(dim=axis, keepdim=True, unbiased=False)
    return (x - m) / torch.sqrt(v + eps)
def _scatter_add(tgt, idx, src, axis=0):
    return tgt.clone().index_add_(axis, idx, src)
def _segment_sum(src, seg, n):
    out = torch.zeros((n,) + src.shape[1:], dtype=src.dtype)
    return out.index_add_(0, seg, src)
def _pad(x, pw):
    flat = tuple(v for pair in reversed(pw) for v in pair)
    return torch.nn.functional.pad(x, flat)

kernel_name = 'standalone__weight_only_int_quip_2__prompt'

def setup_inputs():

    _w = (lambda a: (lambda t: t.to(torch.bfloat16) if t.is_floating_point() else t)(torch.as_tensor(a)))
    B, S, D, F = 1, 2048, 576, 4608
    nbits = max(2, min(4, int(4)))
    G = 64 if 64 > 0 else D
    D = (D // G) * G
    ng = D // G
    qmax = 1 << nbits
    qw = torch.randint(0, qmax, (D, F)).to(torch.int32)
    zp = torch.randint(0, qmax, (ng, F)).to(float)
    sc = torch.abs((lambda *s: torch.randn(*s, dtype=torch.bfloat16) * 0.05)(ng, F)).to(float) * 0.1 + 0.02
    return {
        "x": _w((lambda *s: torch.randn(*s, dtype=torch.bfloat16) * 0.05)(B, S, D)),
        "qw": _w(qw),
        "scales": _w(sc),
        "zeros": _w(zp),
    }

def reference(x, qw, scales, zeros):
    B, S, D = x.shape
    ng, F = scales.shape
    G = D // ng
    s = (lambda x, n, axis: torch.repeat_interleave(x, n, dim=axis))(scales, G, axis=0)
    z = (lambda x, n, axis: torch.repeat_interleave(x, n, dim=axis))(zeros, G, axis=0)
    w = ((lambda x, dt: x.to(dt))(qw, x.dtype) - z) * s
    return torch.einsum("bsd,df->bsf", x, w)
```

```asm
; @launch grid=(256,1,1) block=(512,1,1) lds=146432
.amdgcn_target "amdgcn-amd-amdhsa--gfx950"
.text
.globl standalone__weight_only_int_quip_2__prompt_kernel
.p2align 8
.type standalone__weight_only_int_quip_2__prompt_kernel,@function
standalone__weight_only_int_quip_2__prompt_kernel:
    s_cmp_ge_u32 s2, 256
    s_cbranch_scc1 L_end
    s_load_dwordx4 s[4:7], s[0:1], 0
    s_load_dwordx4 s[8:11], s[0:1], 16
    s_load_dwordx2 s[12:13], s[0:1], 32
    v_lshrrev_b32 v12, 6, v0
    s_and_b32 s50, s2, 7
    s_lshr_b32 s51, s2, 3
    v_readfirstlane_b32 s36, v12
    s_and_b32 s52, s50, 3
    s_lshl_b32 s37, s52, 3
    s_and_b32 s52, s51, 7
    s_add_u32 s37, s37, s52
    s_lshr_b32 s38, s50, 2
    s_lshl_b32 s38, s38, 2
    s_lshr_b32 s52, s51, 3
    s_add_u32 s38, s38, s52
    s_lshl_b32 s50, s38, 8
    s_and_b32 s53, s36, 3
    s_lshl_b32 s51, s53, 6
    s_add_u32 s50, s50, s51
    s_mul_i32 s39, s53, 24576
    s_add_u32 s39, s39, 48128
    s_mul_i32 s51, s37, 288
    s_cmp_ge_u32 s36, 4
    s_cbranch_scc1 L_helper
    s_setprio 1
    s_mul_i32 s48, s50, 9216
    s_add_u32 s48, s48, s51
    v_and_b32 v12, 63, v0
    v_and_b32 v14, 15, v0
    v_lshrrev_b32 v13, 4, v12
    v_lshrrev_b32 v15, 1, v14
    v_xor_b32 v15, v13, v15
    v_lshlrev_b32 v15, 4, v15
    v_lshl_add_u32 v5, v14, 7, v15
    v_add_u32 v5, s39, v5
    v_xor_b32 v6, 64, v5
    v_lshrrev_b32 v16, 1, v14
    v_and_b32 v15, 1, v14
    v_lshlrev_b32 v15, 2, v15
    v_xor_b32 v16, v16, v15
    v_xor_b32 v15, v13, v16
    v_lshlrev_b32 v15, 4, v15
    v_lshl_add_u32 v1, v14, 7, v15
    v_xor_b32 v2, 32, v1
    v_xor_b32 v3, 64, v1
    v_xor_b32 v4, 96, v1
    v_mul_u32_u24 v8, 36864, v13
    v_lshl_add_u32 v7, v14, 4, v8
    v_lshl_add_u32 v8, v14, 1, v8
    v_mul_u32_u24 v56, 57, v0
    v_lshrrev_b32 v56, 12, v56
    v_mul_u32_u24 v57, 72, v56
    v_sub_u32 v57, v0, v57
    v_mul_u32_u24 v58, 9216, v56
    v_lshl_add_u32 v58, v57, 2, v58
    v_mul_u32_u24 v54, 1152, v56
    v_lshl_add_u32 v54, v57, 4, v54
    s_add_u32 s52, s51, 27648
    s_add_u32 s53, s51, 55296
    s_mov_b32 s64, 0x4b800000
    s_waitcnt lgkmcnt(0)
    s_mov_b32 s32, s12
    s_and_b32 s33, s13, 0xffff
    s_mov_b32 s34, 18874368
    s_mov_b32 s35, 0x00020000
    s_mov_b32 s24, s8
    s_and_b32 s25, s9, 0xffff
    s_mov_b32 s26, 82944
    s_mov_b32 s27, 0x00020000
    s_mov_b32 s28, s10
    s_and_b32 s29, s11, 0xffff
    s_mov_b32 s30, 82944
    s_mov_b32 s31, 0x00020000
    buffer_load_dword v48, v58, s[24:27], s51 offen
    buffer_load_dword v51, v58, s[28:31], s51 offen
    buffer_load_dword v49, v58, s[24:27], s52 offen
    buffer_load_dword v52, v58, s[28:31], s52 offen
    buffer_load_dword v50, v58, s[24:27], s53 offen
    buffer_load_dword v53, v58, s[28:31], s53 offen
    s_waitcnt vmcnt(0)
    v_cmp_gt_u32 vcc, 216, v0
    s_and_saveexec_b64 s[62:63], vcc
    s_mov_b64 s[60:61], 0
    v_lshlrev_b32 v60, 16, v48
    v_and_b32 v61, 0xffff0000, v48
    v_lshlrev_b32 v62, 16, v51
    v_and_b32 v63, 0xffff0000, v51
    v_mul_f32 v72, s64, v60
    v_mul_f32_e64 v73, -v62, v60
    v_mul_f32 v74, s64, v61
    v_mul_f32_e64 v75, -v63, v61
    ds_write_b128 v54, v[72:75] offset:36864
    v_rndne_f32 v76, v62
    v_cmp_neq_f32 vcc, v76, v62
    s_or_b64 s[60:61], s[60:61], vcc
    v_and_b32 v76, 0x7fffffff, v62
    v_cmp_lt_u32 vcc, 0x43000000, v76
    s_or_b64 s[60:61], s[60:61], vcc
    v_and_b32 v76, 0x7fffffff, v60
    v_cmp_ne_u32 s[58:59], 0, v76
    v_subrev_u32 v76, 226492416, v76
    v_cmp_le_u32 vcc, 1677721600, v76
    s_and_b64 vcc, vcc, s[58:59]
    s_or_b64 s[60:61], s[60:61], vcc
    v_rndne_f32 v76, v63
    v_cmp_neq_f32 vcc, v76, v63
    s_or_b64 s[60:61], s[60:61], vcc
    v_and_b32 v76, 0x7fffffff, v63
    v_cmp_lt_u32 vcc, 0x43000000, v76
    s_or_b64 s[60:61], s[60:61], vcc
    v_and_b32 v76, 0x7fffffff, v61
    v_cmp_ne_u32 s[58:59], 0, v76
    v_subrev_u32 v76, 226492416, v76
    v_cmp_le_u32 vcc, 1677721600, v76
    s_and_b64 vcc, vcc, s[58:59]
    s_or_b64 s[60:61], s[60:61], vcc
    s_waitcnt lgkmcnt(0)
    v_lshlrev_b32 v60, 16, v49
    v_and_b32 v61, 0xffff0000, v49
    v_lshlrev_b32 v62, 16, v52
    v_and_b32 v63, 0xffff0000, v52
    v_mul_f32 v72, s64, v60
    v_mul_f32_e64 v73, -v62, v60
    v_mul_f32 v74, s64, v61
    v_mul_f32_e64 v75, -v63, v61
    ds_write_b128 v54, v[72:75] offset:40320
    v_rndne_f32 v76, v62
    v_cmp_neq_f32 vcc, v76, v62
    s_or_b64 s[60:61], s[60:61], vcc
    v_and_b32 v76, 0x7fffffff, v62
    v_cmp_lt_u32 vcc, 0x43000000, v76
    s_or_b64 s[60:61], s[60:61], vcc
    v_and_b32 v76, 0x7fffffff, v60
    v_cmp_ne_u32 s[58:59], 0, v76
    v_subrev_u32 v76, 226492416, v76
    v_cmp_le_u32 vcc, 1677721600, v76
    s_and_b64 vcc, vcc, s[58:59]
    s_or_b64 s[60:61], s[60:61], vcc
    v_rndne_f32 v76, v63
    v_cmp_neq_f32 vcc, v76, v63
    s_or_b64 s[60:61], s[60:61], vcc
    v_and_b32 v76, 0x7fffffff, v63
    v_cmp_lt_u32 vcc, 0x43000000, v76
    s_or_b64 s[60:61], s[60:61], vcc
    v_and_b32 v76, 0x7fffffff, v61
    v_cmp_ne_u32 s[58:59], 0, v76
    v_subrev_u32 v76, 226492416, v76
    v_cmp_le_u32 vcc, 1677721600, v76
    s_and_b64 vcc, vcc, s[58:59]
    s_or_b64 s[60:61], s[60:61], vcc
    s_waitcnt lgkmcnt(0)
    v_lshlrev_b32 v60, 16, v50
    v_and_b32 v61, 0xffff0000, v50
    v_lshlrev_b32 v62, 16, v53
    v_and_b32 v63, 0xffff0000, v53
    v_mul_f32 v72, s64, v60
    v_mul_f32_e64 v73, -v62, v60
    v_mul_f32 v74, s64, v61
    v_mul_f32_e64 v75, -v63, v61
    ds_write_b128 v54, v[72:75] offset:43776
    v_rndne_f32 v76, v62
    v_cmp_neq_f32 vcc, v76, v62
    s_or_b64 s[60:61], s[60:61], vcc
    v_and_b32 v76, 0x7fffffff, v62
    v_cmp_lt_u32 vcc, 0x43000000, v76
    s_or_b64 s[60:61], s[60:61], vcc
    v_and_b32 v76, 0x7fffffff, v60
    v_cmp_ne_u32 s[58:59], 0, v76
    v_subrev_u32 v76, 226492416, v76
    v_cmp_le_u32 vcc, 1677721600, v76
    s_and_b64 vcc, vcc, s[58:59]
    s_or_b64 s[60:61], s[60:61], vcc
    v_rndne_f32 v76, v63
    v_cmp_neq_f32 vcc, v76, v63
    s_or_b64 s[60:61], s[60:61], vcc
    v_and_b32 v76, 0x7fffffff, v63
    v_cmp_lt_u32 vcc, 0x43000000, v76
    s_or_b64 s[60:61], s[60:61], vcc
    v_and_b32 v76, 0x7fffffff, v61
    v_cmp_ne_u32 s[58:59], 0, v76
    v_subrev_u32 v76, 226492416, v76
    v_cmp_le_u32 vcc, 1677721600, v76
    s_and_b64 vcc, vcc, s[58:59]
    s_or_b64 s[60:61], s[60:61], vcc
    s_waitcnt lgkmcnt(0)
    s_mov_b64 exec, s[62:63]
    s_cmp_lg_u64 s[60:61], 0
    s_cselect_b32 s58, 1, 0
    s_lshl_b32 s59, s36, 2
    v_mov_b32 v76, s58
    v_mov_b32 v77, s59
    ds_write_b32 v77, v76 offset:47232
    v_mov_b32 v20, 0
    s_waitcnt lgkmcnt(0)
    s_barrier
    ds_read_b128 v[16:19], v20 offset:47232
    s_waitcnt lgkmcnt(0)
    v_or_b32 v16, v16, v17
    v_or3_b32 v16, v16, v18, v19
    s_nop 0
    v_readfirstlane_b32 s58, v16
    s_cmp_eq_u32 s58, 0
    s_cbranch_scc1 L_m_fast
    s_barrier
    v_cmp_gt_u32 vcc, 216, v0
    s_and_saveexec_b64 s[62:63], vcc
    v_lshlrev_b32 v72, 16, v48
    v_and_b32 v74, 0xffff0000, v48
    v_lshlrev_b32 v73, 16, v51
    v_and_b32 v75, 0xffff0000, v51
    v_xor_b32 v73, 0x80000000, v73
    v_xor_b32 v75, 0x80000000, v75
    ds_write_b128 v54, v[72:75] offset:36864
    s_waitcnt lgkmcnt(0)
    v_lshlrev_b32 v72, 16, v49
    v_and_b32 v74, 0xffff0000, v49
    v_lshlrev_b32 v73, 16, v52
    v_and_b32 v75, 0xffff0000, v52
    v_xor_b32 v73, 0x80000000, v73
    v_xor_b32 v75, 0x80000000, v75
    ds_write_b128 v54, v[72:75] offset:40320
    s_waitcnt lgkmcnt(0)
    v_lshlrev_b32 v72, 16, v50
    v_and_b32 v74, 0xffff0000, v50
    v_lshlrev_b32 v73, 16, v53
    v_and_b32 v75, 0xffff0000, v53
    v_xor_b32 v73, 0x80000000, v73
    v_xor_b32 v75, 0x80000000, v75
    ds_write_b128 v54, v[72:75] offset:43776
    s_waitcnt lgkmcnt(0)
    s_mov_b64 exec, s[62:63]
    s_barrier
    s_barrier
L_m_fast:
    ds_read_b128 a[0:3], v5 offset:0
    ds_read_b128 a[4:7], v5 offset:2048
    ds_read_b128 a[8:11], v5 offset:4096
    ds_read_b128 a[12:15], v5 offset:6144
    ds_read_b128 a[32:35], v1 offset:0
    ds_read_b128 a[36:39], v1 offset:2048
    ds_read_b128 a[40:43], v1 offset:4096
    ds_read_b128 a[44:47], v1 offset:6144
    ds_read_b128 a[48:51], v2 offset:8192
    s_waitcnt lgkmcnt(4)
    v_mfma_f32_16x16x32_bf16 v[48:51], a[0:3], a[32:35], 0
    ds_read_b128 a[52:55], v2 offset:10240
    v_mfma_f32_16x16x32_bf16 v[52:55], a[4:7], a[32:35], 0
    ds_read_b128 a[16:19], v6 offset:0
    v_mfma_f32_16x16x32_bf16 v[56:59], a[8:11], a[32:35], 0
    ds_read_b128 a[20:23], v6 offset:2048
    v_mfma_f32_16x16x32_bf16 v[60:63], a[12:15], a[32:35], 0
    ds_read_b128 a[24:27], v6 offset:4096
    s_waitcnt lgkmcnt(7)
    v_mfma_f32_16x16x32_bf16 v[64:67], a[0:3], a[36:39], 0
    ds_read_b128 a[32:35], v2 offset:12288
    v_mfma_f32_16x16x32_bf16 v[68:71], a[4:7], a[36:39], 0
    ds_read_b128 a[28:31], v6 offset:6144
    v_mfma_f32_16x16x32_bf16 v[72:75], a[8:11], a[36:39], 0
    v_mfma_f32_16x16x32_bf16 v[76:79], a[12:15], a[36:39], 0
    s_waitcnt lgkmcnt(8)
    v_mfma_f32_16x16x32_bf16 v[80:83], a[0:3], a[40:43], 0
    ds_read_b128 a[36:39], v2 offset:14336
    v_mfma_f32_16x16x32_bf16 v[84:87], a[4:7], a[40:43], 0
    v_mfma_f32_16x16x32_bf16 v[88:91], a[8:11], a[40:43], 0
    v_mfma_f32_16x16x32_bf16 v[92:95], a[12:15], a[40:43], 0
    s_waitcnt lgkmcnt(8)
    v_mfma_f32_16x16x32_bf16 v[96:99], a[0:3], a[44:47], 0
    ds_read_b128 a[40:43], v1 offset:16384
    v_mfma_f32_16x16x32_bf16 v[100:103], a[4:7], a[44:47], 0
    v_mfma_f32_16x16x32_bf16 v[104:107], a[8:11], a[44:47], 0
    v_mfma_f32_16x16x32_bf16 v[108:111], a[12:15], a[44:47], 0
    s_waitcnt lgkmcnt(8)
    v_mfma_f32_16x16x32_bf16 v[112:115], a[0:3], a[48:51], 0
    ds_read_b128 a[44:47], v3 offset:0
    v_mfma_f32_16x16x32_bf16 v[116:119], a[4:7], a[48:51], 0
    v_mfma_f32_16x16x32_bf16 v[120:123], a[8:11], a[48:51], 0
    v_mfma_f32_16x16x32_bf16 v[124:127], a[12:15], a[48:51], 0
    s_waitcnt lgkmcnt(8)
    v_mfma_f32_16x16x32_bf16 v[128:131], a[0:3], a[52:55], 0
    ds_read_b128 a[48:51], v3 offset:2048
    v_mfma_f32_16x16x32_bf16 v[132:135], a[4:7], a[52:55], 0
    v_mfma_f32_16x16x32_bf16 v[136:139], a[8:11], a[52:55], 0
    v_mfma_f32_16x16x32_bf16 v[140:143], a[12:15], a[52:55], 0
    s_waitcnt lgkmcnt(5)
    v_mfma_f32_16x16x32_bf16 v[144:147], a[0:3], a[32:35], 0
    ds_read_b128 a[52:55], v3 offset:4096
    v_mfma_f32_16x16x32_bf16 v[148:151], a[4:7], a[32:35], 0
    v_mfma_f32_16x16x32_bf16 v[152:155], a[8:11], a[32:35], 0
    v_mfma_f32_16x16x32_bf16 v[156:159], a[12:15], a[32:35], 0
    s_waitcnt lgkmcnt(4)
    v_mfma_f32_16x16x32_bf16 v[160:163], a[0:3], a[36:39], 0
    ds_read_b128 a[32:35], v3 offset:6144
    v_mfma_f32_16x16x32_bf16 v[164:167], a[4:7], a[36:39], 0
    v_mfma_f32_16x16x32_bf16 v[168:171], a[8:11], a[36:39], 0
    v_mfma_f32_16x16x32_bf16 v[172:175], a[12:15], a[36:39], 0
    s_waitcnt lgkmcnt(4)
    v_mfma_f32_16x16x32_bf16 v[176:179], a[0:3], a[40:43], 0
    ds_read_b128 a[36:39], v4 offset:8192
    v_mfma_f32_16x16x32_bf16 v[180:183], a[4:7], a[40:43], 0
    v_mfma_f32_16x16x32_bf16 v[184:187], a[8:11], a[40:43], 0
    v_mfma_f32_16x16x32_bf16 v[188:191], a[12:15], a[40:43], 0
    s_waitcnt lgkmcnt(4)
    v_mfma_f32_16x16x32_bf16 v[48:51], a[16:19], a[44:47], v[48:51]
    ds_read_b128 a[40:43], v4 offset:10240
    v_mfma_f32_16x16x32_bf16 v[52:55], a[20:23], a[44:47], v[52:55]
    v_mfma_f32_16x16x32_bf16 v[56:59], a[24:27], a[44:47], v[56:59]
    v_mfma_f32_16x16x32_bf16 v[60:63], a[28:31], a[44:47], v[60:63]
    s_waitcnt lgkmcnt(4)
    v_mfma_f32_16x16x32_bf16 v[64:67], a[16:19], a[48:51], v[64:67]
    ds_read_b128 a[44:47], v4 offset:12288
    v_mfma_f32_16x16x32_bf16 v[68:71], a[20:23], a[48:51], v[68:71]
    v_mfma_f32_16x16x32_bf16 v[72:75], a[24:27], a[48:51], v[72:75]
    v_mfma_f32_16x16x32_bf16 v[76:79], a[28:31], a[48:51], v[76:79]
    s_waitcnt lgkmcnt(4)
    v_mfma_f32_16x16x32_bf16 v[80:83], a[16:19], a[52:55], v[80:83]
    ds_read_b128 a[48:51], v4 offset:14336
    v_mfma_f32_16x16x32_bf16 v[84:87], a[20:23], a[52:55], v[84:87]
    v_mfma_f32_16x16x32_bf16 v[88:91], a[24:27], a[52:55], v[88:91]
    v_mfma_f32_16x16x32_bf16 v[92:95], a[28:31], a[52:55], v[92:95]
    s_waitcnt lgkmcnt(4)
    v_mfma_f32_16x16x32_bf16 v[96:99], a[16:19], a[32:35], v[96:99]
    ds_read_b128 a[52:55], v3 offset:16384
    v_mfma_f32_16x16x32_bf16 v[100:103], a[20:23], a[32:35], v[100:103]
    v_mfma_f32_16x16x32_bf16 v[104:107], a[24:27], a[32:35], v[104:107]
    v_mfma_f32_16x16x32_bf16 v[108:111], a[28:31], a[32:35], v[108:111]
    s_waitcnt lgkmcnt(4)
    v_mfma_f32_16x16x32_bf16 v[112:115], a[16:19], a[36:39], v[112:115]
    v_mfma_f32_16x16x32_bf16 v[116:119], a[20:23], a[36:39], v[116:119]
    v_mfma_f32_16x16x32_bf16 v[120:123], a[24:27], a[36:39], v[120:123]
    v_mfma_f32_16x16x32_bf16 v[124:127], a[28:31], a[36:39], v[124:127]
    s_waitcnt lgkmcnt(0)
    s_barrier
    v_mfma_f32_16x16x32_bf16 v[128:131], a[16:19], a[40:43], v[128:131]
    ds_read_b128 a[32:35], v1 offset:18432
    v_mfma_f32_16x16x32_bf16 v[132:135], a[20:23], a[40:43], v[132:135]
    ds_read_b128 a[36:39], v1 offset:20480
    v_mfma_f32_16x16x32_bf16 v[136:139], a[24:27], a[40:43], v[136:139]
    ds_read_b128 a[0:3], v5 offset:8192
    v_mfma_f32_16x16x32_bf16 v[140:143], a[28:31], a[40:43], v[140:143]
    ds_read_b128 a[4:7], v5 offset:10240
    v_mfma_f32_16x16x32_bf16 v[144:147], a[16:19], a[44:47], v[144:147]
    ds_read_b128 a[40:43], v1 offset:22528
    v_mfma_f32_16x16x32_bf16 v[148:151], a[20:23], a[44:47], v[148:151]
    ds_read_b128 a[8:11], v5 offset:12288
    v_mfma_f32_16x16x32_bf16 v[152:155], a[24:27], a[44:47], v[152:155]
    ds_read_b128 a[12:15], v5 offset:14336
    v_mfma_f32_16x16x32_bf16 v[156:159], a[28:31], a[44:47], v[156:159]
    v_mfma_f32_16x16x32_bf16 v[160:163], a[16:19], a[48:51], v[160:163]
    ds_read_b128 a[44:47], v1 offset:24576
    v_mfma_f32_16x16x32_bf16 v[164:167], a[20:23], a[48:51], v[164:167]
    v_mfma_f32_16x16x32_bf16 v[168:171], a[24:27], a[48:51], v[168:171]
    v_mfma_f32_16x16x32_bf16 v[172:175], a[28:31], a[48:51], v[172:175]
    v_mfma_f32_16x16x32_bf16 v[176:179], a[16:19], a[52:55], v[176:179]
    ds_read_b128 a[48:51], v2 offset:26624
    v_mfma_f32_16x16x32_bf16 v[180:183], a[20:23], a[52:55], v[180:183]
    v_mfma_f32_16x16x32_bf16 v[184:187], a[24:27], a[52:55], v[184:187]
    v_mfma_f32_16x16x32_bf16 v[188:191], a[28:31], a[52:55], v[188:191]
    s_waitcnt lgkmcnt(2)
    v_mfma_f32_16x16x32_bf16 v[48:51], a[0:3], a[32:35], v[48:51]
    ds_read_b128 a[52:55], v2 offset:28672
    v_mfma_f32_16x16x32_bf16 v[52:55], a[4:7], a[32:35], v[52:55]
    ds_read_b128 a[16:19], v6 offset:8192
    v_mfma_f32_16x16x32_bf16 v[56:59], a[8:11], a[32:35], v[56:59]
    ds_read_b128 a[20:23], v6 offset:10240
    v_mfma_f32_16x16x32_bf16 v[60:63], a[12:15], a[32:35], v[60:63]
    ds_read_b128 a[24:27], v6 offset:12288
    v_mfma_f32_16x16x32_bf16 v[64:67], a[0:3], a[36:39], v[64:67]
    ds_read_b128 a[32:35], v2 offset:30720
    v_mfma_f32_16x16x32_bf16 v[68:71], a[4:7], a[36:39], v[68:71]
    ds_read_b128 a[28:31], v6 offset:14336
    v_mfma_f32_16x16x32_bf16 v[72:75], a[8:11], a[36:39], v[72:75]
    v_mfma_f32_16x16x32_bf16 v[76:79], a[12:15], a[36:39], v[76:79]
    v_mfma_f32_16x16x32_bf16 v[80:83], a[0:3], a[40:43], v[80:83]
    ds_read_b128 a[36:39], v2 offset:32768
    v_mfma_f32_16x16x32_bf16 v[84:87], a[4:7], a[40:43], v[84:87]
    v_mfma_f32_16x16x32_bf16 v[88:91], a[8:11], a[40:43], v[88:91]
    v_mfma_f32_16x16x32_bf16 v[92:95], a[12:15], a[40:43], v[92:95]
    s_waitcnt lgkmcnt(8)
    v_mfma_f32_16x16x32_bf16 v[96:99], a[0:3], a[44:47], v[96:99]
    ds_read_b128 a[40:43], v1 offset:34816
    v_mfma_f32_16x16x32_bf16 v[100:103], a[4:7], a[44:47], v[100:103]
    v_mfma_f32_16x16x32_bf16 v[104:107], a[8:11], a[44:47], v[104:107]
    v_mfma_f32_16x16x32_bf16 v[108:111], a[12:15], a[44:47], v[108:111]
    s_waitcnt lgkmcnt(8)
    v_mfma_f32_16x16x32_bf16 v[112:115], a[0:3], a[48:51], v[112:115]
    ds_read_b128 a[44:47], v3 offset:18432
    v_mfma_f32_16x16x32_bf16 v[116:119], a[4:7], a[48:51], v[116:119]
    v_mfma_f32_16x16x32_bf16 v[120:123], a[8:11], a[48:51], v[120:123]
    v_mfma_f32_16x16x32_bf16 v[124:127], a[12:15], a[48:51], v[124:127]
    s_waitcnt lgkmcnt(8)
    v_mfma_f32_16x16x32_bf16 v[128:131], a[0:3], a[52:55], v[128:131]
    ds_read_b128 a[48:51], v3 offset:20480
    v_mfma_f32_16x16x32_bf16 v[132:135], a[4:7], a[52:55], v[132:135]
    v_mfma_f32_16x16x32_bf16 v[136:139], a[8:11], a[52:55], v[136:139]
    v_mfma_f32_16x16x32_bf16 v[140:143], a[12:15], a[52:55], v[140:143]
    s_waitcnt lgkmcnt(5)
    v_mfma_f32_16x16x32_bf16 v[144:147], a[0:3], a[32:35], v[144:147]
    ds_read_b128 a[52:55], v3 offset:22528
    v_mfma_f32_16x16x32_bf16 v[148:151], a[4:7], a[32:35], v[148:151]
    v_mfma_f32_16x16x32_bf16 v[152:155], a[8:11], a[32:35], v[152:155]
    v_mfma_f32_16x16x32_bf16 v[156:159], a[12:15], a[32:35], v[156:159]
    s_waitcnt lgkmcnt(4)
    v_mfma_f32_16x16x32_bf16 v[160:163], a[0:3], a[36:39], v[160:163]
    ds_read_b128 a[32:35], v3 offset:24576
    v_mfma_f32_16x16x32_bf16 v[164:167], a[4:7], a[36:39], v[164:167]
    v_mfma_f32_16x16x32_bf16 v[168:171], a[8:11], a[36:39], v[168:171]
    v_mfma_f32_16x16x32_bf16 v[172:175], a[12:15], a[36:39], v[172:175]
    s_waitcnt lgkmcnt(4)
    v_mfma_f32_16x16x32_bf16 v[176:179], a[0:3], a[40:43], v[176:179]
    ds_read_b128 a[36:39], v4 offset:26624
    v_mfma_f32_16x16x32_bf16 v[180:183], a[4:7], a[40:43], v[180:183]
    v_mfma_f32_16x16x32_bf16 v[184:187], a[8:11], a[40:43], v[184:187]
    v_mfma_f32_16x16x32_bf16 v[188:191], a[12:15], a[40:43], v[188:191]
    s_waitcnt lgkmcnt(4)
    v_mfma_f32_16x16x32_bf16 v[48:51], a[16:19], a[44:47], v[48:51]
    ds_read_b128 a[40:43], v4 offset:28672
    v_mfma_f32_16x16x32_bf16 v[52:55], a[20:23], a[44:47], v[52:55]
    v_mfma_f32_16x16x32_bf16 v[56:59], a[24:27], a[44:47], v[56:59]
    v_mfma_f32_16x16x32_bf16 v[60:63], a[28:31], a[44:47], v[60:63]
    s_waitcnt lgkmcnt(4)
    v_mfma_f32_16x16x32_bf16 v[64:67], a[16:19], a[48:51], v[64:67]
    ds_read_b128 a[44:47], v4 offset:30720
    v_mfma_f32_16x16x32_bf16 v[68:71], a[20:23], a[48:51], v[68:71]
    v_mfma_f32_16x16x32_bf16 v[72:75], a[24:27], a[48:51], v[72:75]
    v_mfma_f32_16x16x32_bf16 v[76:79], a[28:31], a[48:51], v[76:79]
    s_waitcnt lgkmcnt(4)
    v_mfma_f32_16x16x32_bf16 v[80:83], a[16:19], a[52:55], v[80:83]
    ds_read_b128 a[48:51], v4 offset:32768
    v_mfma_f32_16x16x32_bf16 v[84:87], a[20:23], a[52:55], v[84:87]
    v_mfma_f32_16x16x32_bf16 v[88:91], a[24:27], a[52:55], v[88:91]
    v_mfma_f32_16x16x32_bf16 v[92:95], a[28:31], a[52:55], v[92:95]
    s_waitcnt lgkmcnt(4)
    v_mfma_f32_16x16x32_bf16 v[96:99], a[16:19], a[32:35], v[96:99]
    ds_read_b128 a[52:55], v3 offset:34816
    v_mfma_f32_16x16x32_bf16 v[100:103], a[20:23], a[32:35], v[100:103]
    v_mfma_f32_16x16x32_bf16 v[104:107], a[24:27], a[32:35], v[104:107]
    v_mfma_f32_16x16x32_bf16 v[108:111], a[28:31], a[32:35], v[108:111]
    s_waitcnt lgkmcnt(4)
    v_mfma_f32_16x16x32_bf16 v[112:115], a[16:19], a[36:39], v[112:115]
    v_mfma_f32_16x16x32_bf16 v[116:119], a[20:23], a[36:39], v[116:119]
    v_mfma_f32_16x16x32_bf16 v[120:123], a[24:27], a[36:39], v[120:123]
    v_mfma_f32_16x16x32_bf16 v[124:127], a[28:31], a[36:39], v[124:127]
    s_waitcnt lgkmcnt(0)
    s_barrier
    v_mfma_f32_16x16x32_bf16 v[128:131], a[16:19], a[40:43], v[128:131]
    ds_read_b128 a[32:35], v1 offset:0
    v_mfma_f32_16x16x32_bf16 v[132:135], a[20:23], a[40:43], v[132:135]
    ds_read_b128 a[36:39], v1 offset:2048
    v_mfma_f32_16x16x32_bf16 v[136:139], a[24:27], a[40:43], v[136:139]
    ds_read_b128 a[0:3], v5 offset:16384
    v_mfma_f32_16x16x32_bf16 v[140:143], a[28:31], a[40:43], v[140:143]
    ds_read_b128 a[4:7], v5 offset:18432
    v_mfma_f32_16x16x32_bf16 v[144:147], a[16:19], a[44:47], v[144:147]
    ds_read_b128 a[40:43], v1 offset:4096
    v_mfma_f32_16x16x32_bf16 v[148:151], a[20:23], a[44:47], v[148:151]
    ds_read_b128 a[8:11], v5 offset:20480
    v_mfma_f32_16x16x32_bf16 v[152:155], a[24:27], a[44:47], v[152:155]
    ds_read_b128 a[12:15], v5 offset:22528
    v_mfma_f32_16x16x32_bf16 v[156:159], a[28:31], a[44:47], v[156:159]
    v_mfma_f32_16x16x32_bf16 v[160:163], a[16:19], a[48:51], v[160:163]
    ds_read_b128 a[44:47], v1 offset:6144
    v_mfma_f32_16x16x32_bf16 v[164:167], a[20:23], a[48:51], v[164:167]
    v_mfma_f32_16x16x32_bf16 v[168:171], a[24:27], a[48:51], v[168:171]
    v_mfma_f32_16x16x32_bf16 v[172:175], a[28:31], a[48:51], v[172:175]
    v_mfma_f32_16x16x32_bf16 v[176:179], a[16:19], a[52:55], v[176:179]
    ds_read_b128 a[48:51], v2 offset:8192
    v_mfma_f32_16x16x32_bf16 v[180:183], a[20:23], a[52:55], v[180:183]
    v_mfma_f32_16x16x32_bf16 v[184:187], a[24:27], a[52:55], v[184:187]
    v_mfma_f32_16x16x32_bf16 v[188:191], a[28:31], a[52:55], v[188:191]
    s_waitcnt lgkmcnt(2)
    v_mfma_f32_16x16x32_bf16 v[48:51], a[0:3], a[32:35], v[48:51]
    ds_read_b128 a[52:55], v2 offset:10240
    v_mfma_f32_16x16x32_bf16 v[52:55], a[4:7], a[32:35], v[52:55]
    ds_read_b128 a[16:19], v6 offset:16384
    v_mfma_f32_16x16x32_bf16 v[56:59], a[8:11], a[32:35], v[56:59]
    ds_read_b128 a[20:23], v6 offset:18432
    v_mfma_f32_16x16x32_bf16 v[60:63], a[12:15], a[32:35], v[60:63]
    ds_read_b128 a[24:27], v6 offset:20480
    v_mfma_f32_16x16x32_bf16 v[64:67], a[0:3], a[36:39], v[64:67]
    ds_read_b128 a[32:35], v2 offset:12288
    v_mfma_f32_16x16x32_bf16 v[68:71], a[4:7], a[36:39], v[68:71]
    ds_read_b128 a[28:31], v6 offset:22528
    v_mfma_f32_16x16x32_bf16 v[72:75], a[8:11], a[36:39], v[72:75]
    v_mfma_f32_16x16x32_bf16 v[76:79], a[12:15], a[36:39], v[76:79]
    v_mfma_f32_16x16x32_bf16 v[80:83], a[0:3], a[40:43], v[80:83]
    ds_read_b128 a[36:39], v2 offset:14336
    v_mfma_f32_16x16x32_bf16 v[84:87], a[4:7], a[40:43], v[84:87]
    v_mfma_f32_16x16x32_bf16 v[88:91], a[8:11], a[40:43], v[88:91]
    v_mfma_f32_16x16x32_bf16 v[92:95], a[12:15], a[40:43], v[92:95]
    s_waitcnt lgkmcnt(8)
    v_mfma_f32_16x16x32_bf16 v[96:99], a[0:3], a[44:47], v[96:99]
    ds_read_b128 a[40:43], v1 offset:16384
    v_mfma_f32_16x16x32_bf16 v[100:103], a[4:7], a[44:47], v[100:103]
    v_mfma_f32_16x16x32_bf16 v[104:107], a[8:11], a[44:47], v[104:107]
    v_mfma_f32_16x16x32_bf16 v[108:111], a[12:15], a[44:47], v[108:111]
    s_waitcnt lgkmcnt(8)
    v_mfma_f32_16x16x32_bf16 v[112:115], a[0:3], a[48:51], v[112:115]
    ds_read_b128 a[44:47], v3 offset:0
    v_mfma_f32_16x16x32_bf16 v[116:119], a[4:7], a[48:51], v[116:119]
    v_mfma_f32_16x16x32_bf16 v[120:123], a[8:11], a[48:51], v[120:123]
    v_mfma_f32_16x16x32_bf16 v[124:127], a[12:15], a[48:51], v[124:127]
    s_waitcnt lgkmcnt(8)
    v_mfma_f32_16x16x32_bf16 v[128:131], a[0:3], a[52:55], v[128:131]
    ds_read_b128 a[48:51], v3 offset:2048
    v_mfma_f32_16x16x32_bf16 v[132:135], a[4:7], a[52:55], v[132:135]
    v_mfma_f32_16x16x32_bf16 v[136:139], a[8:11], a[52:55], v[136:139]
    v_mfma_f32_16x16x32_bf16 v[140:143], a[12:15], a[52:55], v[140:143]
    s_waitcnt lgkmcnt(5)
    v_mfma_f32_16x16x32_bf16 v[144:147], a[0:3], a[32:35], v[144:147]
    ds_read_b128 a[52:55], v3 offset:4096
    v_mfma_f32_16x16x32_bf16 v[148:151], a[4:7], a[32:35], v[148:151]
    v_mfma_f32_16x16x32_bf16 v[152:155], a[8:11], a[32:35], v[152:155]
    v_mfma_f32_16x16x32_bf16 v[156:159], a[12:15], a[32:35], v[156:159]
    s_waitcnt lgkmcnt(4)
    v_mfma_f32_16x16x32_bf16 v[160:163], a[0:3], a[36:39], v[160:163]
    ds_read_b128 a[32:35], v3 offset:6144
    v_mfma_f32_16x16x32_bf16 v[164:167], a[4:7], a[36:39], v[164:167]
    v_mfma_f32_16x16x32_bf16 v[168:171], a[8:11], a[36:39], v[168:171]
    v_mfma_f32_16x16x32_bf16 v[172:175], a[12:15], a[36:39], v[172:175]
    s_waitcnt lgkmcnt(4)
    v_mfma_f32_16x16x32_bf16 v[176:179], a[0:3], a[40:43], v[176:179]
    ds_read_b128 a[36:39], v4 offset:8192
    v_mfma_f32_16x16x32_bf16 v[180:183], a[4:7], a[40:43], v[180:183]
    v_mfma_f32_16x16x32_bf16 v[184:187], a[8:11], a[40:43], v[184:187]
    v_mfma_f32_16x16x32_bf16 v[188:191], a[12:15], a[40:43], v[188:191]
    s_waitcnt lgkmcnt(4)
    v_mfma_f32_16x16x32_bf16 v[48:51], a[16:19], a[44:47], v[48:51]
    ds_read_b128 a[40:43], v4 offset:10240
    v_mfma_f32_16x16x32_bf16 v[52:55], a[20:23], a[44:47], v[52:55]
    v_mfma_f32_16x16x32_bf16 v[56:59], a[24:27], a[44:47], v[56:59]
    v_mfma_f32_16x16x32_bf16 v[60:63], a[28:31], a[44:47], v[60:63]
    s_waitcnt lgkmcnt(4)
    v_mfma_f32_16x16x32_bf16 v[64:67], a[16:19], a[48:51], v[64:67]
    ds_read_b128 a[44:47], v4 offset:12288
    v_mfma_f32_16x16x32_bf16 v[68:71], a[20:23], a[48:51], v[68:71]
    v_mfma_f32_16x16x32_bf16 v[72:75], a[24:27], a[48:51], v[72:75]
    v_mfma_f32_16x16x32_bf16 v[76:79], a[28:31], a[48:51], v[76:79]
    s_waitcnt lgkmcnt(4)
    v_mfma_f32_16x16x32_bf16 v[80:83], a[16:19], a[52:55], v[80:83]
    ds_read_b128 a[48:51], v4 offset:14336
    v_mfma_f32_16x16x32_bf16 v[84:87], a[20:23], a[52:55], v[84:87]
    v_mfma_f32_16x16x32_bf16 v[88:91], a[24:27], a[52:55], v[88:91]
    v_mfma_f32_16x16x32_bf16 v[92:95], a[28:31], a[52:55], v[92:95]
    s_waitcnt lgkmcnt(4)
    v_mfma_f32_16x16x32_bf16 v[96:99], a[16:19], a[32:35], v[96:99]
    ds_read_b128 a[52:55], v3 offset:16384
    v_mfma_f32_16x16x32_bf16 v[100:103], a[20:23], a[32:35], v[100:103]
    v_mfma_f32_16x16x32_bf16 v[104:107], a[24:27], a[32:35], v[104:107]
    v_mfma_f32_16x16x32_bf16 v[108:111], a[28:31], a[32:35], v[108:111]
    s_waitcnt lgkmcnt(4)
    v_mfma_f32_16x16x32_bf16 v[112:115], a[16:19], a[36:39], v[112:115]
    v_mfma_f32_16x16x32_bf16 v[116:119], a[20:23], a[36:39], v[116:119]
    v_mfma_f32_16x16x32_bf16 v[120:123], a[24:27], a[36:39], v[120:123]
    v_mfma_f32_16x16x32_bf16 v[124:127], a[28:31], a[36:39], v[124:127]
    s_waitcnt lgkmcnt(0)
    s_barrier
    v_mfma_f32_16x16x32_bf16 v[128:131], a[16:19], a[40:43], v[128:131]
    ds_read_b128 a[32:35], v1 offset:18432
    v_mfma_f32_16x16x32_bf16 v[132:135], a[20:23], a[40:43], v[132:135]
    ds_read_b128 a[36:39], v1 offset:20480
    v_mfma_f32_16x16x32_bf16 v[136:139], a[24:27], a[40:43], v[136:139]
    ds_read_b128 a[0:3], v5 offset:0
    v_mfma_f32_16x16x32_bf16 v[140:143], a[28:31], a[40:43], v[140:143]
    ds_read_b128 a[4:7], v5 offset:2048
    v_mfma_f32_16x16x32_bf16 v[144:147], a[16:19], a[44:47], v[144:147]
    ds_read_b128 a[40:43], v1 offset:22528
    v_mfma_f32_16x16x32_bf16 v[148:151], a[20:23], a[44:47], v[148:151]
    ds_read_b128 a[8:11], v5 offset:4096
    v_mfma_f32_16x16x32_bf16 v[152:155], a[24:27], a[44:47], v[152:155]
    ds_read_b128 a[12:15], v5 offset:6144
    v_mfma_f32_16x16x32_bf16 v[156:159], a[28:31], a[44:47], v[156:159]
    v_mfma_f32_16x16x32_bf16 v[160:163], a[16:19], a[48:51], v[160:163]
    ds_read_b128 a[44:47], v1 offset:24576
    v_mfma_f32_16x16x32_bf16 v[164:167], a[20:23], a[48:51], v[164:167]
    v_mfma_f32_16x16x32_bf16 v[168:171], a[24:27], a[48:51], v[168:171]
    v_mfma_f32_16x16x32_bf16 v[172:175], a[28:31], a[48:51], v[172:175]
    v_mfma_f32_16x16x32_bf16 v[176:179], a[16:19], a[52:55], v[176:179]
    ds_read_b128 a[48:51], v2 offset:26624
    v_mfma_f32_16x16x32_bf16 v[180:183], a[20:23], a[52:55], v[180:183]
    v_mfma_f32_16x16x32_bf16 v[184:187], a[24:27], a[52:55], v[184:187]
    v_mfma_f32_16x16x32_bf16 v[188:191], a[28:31], a[52:55], v[188:191]
    s_waitcnt lgkmcnt(2)
    v_mfma_f32_16x16x32_bf16 v[48:51], a[0:3], a[32:35], v[48:51]
    ds_read_b128 a[52:55], v2 offset:28672
    v_mfma_f32_16x16x32_bf16 v[52:55], a[4:7], a[32:35], v[52:55]
    ds_read_b128 a[16:19], v6 offset:0
    v_mfma_f32_16x16x32_bf16 v[56:59], a[8:11], a[32:35], v[56:59]
    ds_read_b128 a[20:23], v6 offset:2048
    v_mfma_f32_16x16x32_bf16 v[60:63], a[12:15], a[32:35], v[60:63]
    ds_read_b128 a[24:27], v6 offset:4096
    v_mfma_f32_16x16x32_bf16 v[64:67], a[0:3], a[36:39], v[64:67]
    ds_read_b128 a[32:35], v2 offset:30720
    v_mfma_f32_16x16x32_bf16 v[68:71], a[4:7], a[36:39], v[68:71]
    ds_read_b128 a[28:31], v6 offset:6144
    v_mfma_f32_16x16x32_bf16 v[72:75], a[8:11], a[36:39], v[72:75]
    v_mfma_f32_16x16x32_bf16 v[76:79], a[12:15], a[36:39], v[76:79]
    v_mfma_f32_16x16x32_bf16 v[80:83], a[0:3], a[40:43], v[80:83]
    ds_read_b128 a[36:39], v2 offset:32768
    v_mfma_f32_16x16x32_bf16 v[84:87], a[4:7], a[40:43], v[84:87]
    v_mfma_f32_16x16x32_bf16 v[88:91], a[8:11], a[40:43], v[88:91]
    v_mfma_f32_16x16x32_bf16 v[92:95], a[12:15], a[40:43], v[92:95]
    s_waitcnt lgkmcnt(8)
    v_mfma_f32_16x16x32_bf16 v[96:99], a[0:3], a[44:47], v[96:99]
    ds_read_b128 a[40:43], v1 offset:34816
    v_mfma_f32_16x16x32_bf16 v[100:103], a[4:7], a[44:47], v[100:103]
    v_mfma_f32_16x16x32_bf16 v[104:107], a[8:11], a[44:47], v[104:107]
    v_mfma_f32_16x16x32_bf16 v[108:111], a[12:15], a[44:47], v[108:111]
    s_waitcnt lgkmcnt(8)
    v_mfma_f32_16x16x32_bf16 v[112:115], a[0:3], a[48:51], v[112:115]
    ds_read_b128 a[44:47], v3 offset:18432
    v_mfma_f32_16x16x32_bf16 v[116:119], a[4:7], a[48:51], v[116:119]
    v_mfma_f32_16x16x32_bf16 v[120:123], a[8:11], a[48:51], v[120:123]
    v_mfma_f32_16x16x32_bf16 v[124:127], a[12:15], a[48:51], v[124:127]
    s_waitcnt lgkmcnt(8)
    v_mfma_f32_16x16x32_bf16 v[128:131], a[0:3], a[52:55], v[128:131]
    ds_read_b128 a[48:51], v3 offset:20480
    v_mfma_f32_16x16x32_bf16 v[132:135], a[4:7], a[52:55], v[132:135]
    v_mfma_f32_16x16x32_bf16 v[136:139], a[8:11], a[52:55], v[136:139]
    v_mfma_f32_16x16x32_bf16 v[140:143], a[12:15], a[52:55], v[140:143]
    s_waitcnt lgkmcnt(5)
    v_mfma_f32_16x16x32_bf16 v[144:147], a[0:3], a[32:35], v[144:147]
    ds_read_b128 a[52:55], v3 offset:22528
    v_mfma_f32_16x16x32_bf16 v[148:151], a[4:7], a[32:35], v[148:151]
    v_mfma_f32_16x16x32_bf16 v[152:155], a[8:11], a[32:35], v[152:155]
    v_mfma_f32_16x16x32_bf16 v[156:159], a[12:15], a[32:35], v[156:159]
    s_waitcnt lgkmcnt(4)
    v_mfma_f32_16x16x32_bf16 v[160:163], a[0:3], a[36:39], v[160:163]
    ds_read_b128 a[32:35], v3 offset:24576
    v_mfma_f32_16x16x32_bf16 v[164:167], a[4:7], a[36:39], v[164:167]
    v_mfma_f32_16x16x32_bf16 v[168:171], a[8:11], a[36:39], v[168:171]
    v_mfma_f32_16x16x32_bf16 v[172:175], a[12:15], a[36:39], v[172:175]
    s_waitcnt lgkmcnt(4)
    v_mfma_f32_16x16x32_bf16 v[176:179], a[0:3], a[40:43], v[176:179]
    ds_read_b128 a[36:39], v4 offset:26624
    v_mfma_f32_16x16x32_bf16 v[180:183], a[4:7], a[40:43], v[180:183]
    v_mfma_f32_16x16x32_bf16 v[184:187], a[8:11], a[40:43], v[184:187]
    v_mfma_f32_16x16x32_bf16 v[188:191], a[12:15], a[40:43], v[188:191]
    s_waitcnt lgkmcnt(4)
    v_mfma_f32_16x16x32_bf16 v[48:51], a[16:19], a[44:47], v[48:51]
    ds_read_b128 a[40:43], v4 offset:28672
    v_mfma_f32_16x16x32_bf16 v[52:55], a[20:23], a[44:47], v[52:55]
    v_mfma_f32_16x16x32_bf16 v[56:59], a[24:27], a[44:47], v[56:59]
    v_mfma_f32_16x16x32_bf16 v[60:63], a[28:31], a[44:47], v[60:63]
    s_waitcnt lgkmcnt(4)
    v_mfma_f32_16x16x32_bf16 v[64:67], a[16:19], a[48:51], v[64:67]
    ds_read_b128 a[44:47], v4 offset:30720
    v_mfma_f32_16x16x32_bf16 v[68:71], a[20:23], a[48:51], v[68:71]
    v_mfma_f32_16x16x32_bf16 v[72:75], a[24:27], a[48:51], v[72:75]
    v_mfma_f32_16x16x32_bf16 v[76:79], a[28:31], a[48:51], v[76:79]
    s_waitcnt lgkmcnt(4)
    v_mfma_f32_16x16x32_bf16 v[80:83], a[16:19], a[52:55], v[80:83]
    ds_read_b128 a[48:51], v4 offset:32768
    v_mfma_f32_16x16x32_bf16 v[84:87], a[20:23], a[52:55], v[84:87]
    v_mfma_f32_16x16x32_bf16 v[88:91], a[24:27], a[52:55], v[88:91]
    v_mfma_f32_16x16x32_bf16 v[92:95], a[28:31], a[52:55], v[92:95]
    s_waitcnt lgkmcnt(4)
    v_mfma_f32_16x16x32_bf16 v[96:99], a[16:19], a[32:35], v[96:99]
    ds_read_b128 a[52:55], v3 offset:34816
    v_mfma_f32_16x16x32_bf16 v[100:103], a[20:23], a[32:35], v[100:103]
    v_mfma_f32_16x16x32_bf16 v[104:107], a[24:27], a[32:35], v[104:107]
    v_mfma_f32_16x16x32_bf16 v[108:111], a[28:31], a[32:35], v[108:111]
    s_waitcnt lgkmcnt(4)
    v_mfma_f32_16x16x32_bf16 v[112:115], a[16:19], a[36:39], v[112:115]
    v_mfma_f32_16x16x32_bf16 v[116:119], a[20:23], a[36:39], v[116:119]
    v_mfma_f32_16x16x32_bf16 v[120:123], a[24:27], a[36:39], v[120:123]
    v_mfma_f32_16x16x32_bf16 v[124:127], a[28:31], a[36:39], v[124:127]
    s_waitcnt lgkmcnt(0)
    s_barrier
    v_mfma_f32_16x16x32_bf16 v[128:131], a[16:19], a[40:43], v[128:131]
    ds_read_b128 a[32:35], v1 offset:0
    v_mfma_f32_16x16x32_bf16 v[132:135], a[20:23], a[40:43], v[132:135]
    ds_read_b128 a[36:39], v1 offset:2048
    v_mfma_f32_16x16x32_bf16 v[136:139], a[24:27], a[40:43], v[136:139]
    ds_read_b128 a[0:3], v5 offset:8192
    v_mfma_f32_16x16x32_bf16 v[140:143], a[28:31], a[40:43], v[140:143]
    ds_read_b128 a[4:7], v5 offset:10240
    v_mfma_f32_16x16x32_bf16 v[144:147], a[16:19], a[44:47], v[144:147]
    ds_read_b128 a[40:43], v1 offset:4096
    v_mfma_f32_16x16x32_bf16 v[148:151], a[20:23], a[44:47], v[148:151]
    ds_read_b128 a[8:11], v5 offset:12288
    v_mfma_f32_16x16x32_bf16 v[152:155], a[24:27], a[44:47], v[152:155]
    ds_read_b128 a[12:15], v5 offset:14336
    v_mfma_f32_16x16x32_bf16 v[156:159], a[28:31], a[44:47], v[156:159]
    v_mfma_f32_16x16x32_bf16 v[160:163], a[16:19], a[48:51], v[160:163]
    ds_read_b128 a[44:47], v1 offset:6144
    v_mfma_f32_16x16x32_bf16 v[164:167], a[20:23], a[48:51], v[164:167]
    v_mfma_f32_16x16x32_bf16 v[168:171], a[24:27], a[48:51], v[168:171]
    v_mfma_f32_16x16x32_bf16 v[172:175], a[28:31], a[48:51], v[172:175]
    v_mfma_f32_16x16x32_bf16 v[176:179], a[16:19], a[52:55], v[176:179]
    ds_read_b128 a[48:51], v2 offset:8192
    v_mfma_f32_16x16x32_bf16 v[180:183], a[20:23], a[52:55], v[180:183]
    v_mfma_f32_16x16x32_bf16 v[184:187], a[24:27], a[52:55], v[184:187]
    v_mfma_f32_16x16x32_bf16 v[188:191], a[28:31], a[52:55], v[188:191]
    s_waitcnt lgkmcnt(2)
    v_mfma_f32_16x16x32_bf16 v[48:51], a[0:3], a[32:35], v[48:51]
    ds_read_b128 a[52:55], v2 offset:10240
    v_mfma_f32_16x16x32_bf16 v[52:55], a[4:7], a[32:35], v[52:55]
    ds_read_b128 a[16:19], v6 offset:8192
    v_mfma_f32_16x16x32_bf16 v[56:59], a[8:11], a[32:35], v[56:59]
    ds_read_b128 a[20:23], v6 offset:10240
    v_mfma_f32_16x16x32_bf16 v[60:63], a[12:15], a[32:35], v[60:63]
    ds_read_b128 a[24:27], v6 offset:12288
    v_mfma_f32_16x16x32_bf16 v[64:67], a[0:3], a[36:39], v[64:67]
    ds_read_b128 a[32:35], v2 offset:12288
    v_mfma_f32_16x16x32_bf16 v[68:71], a[4:7], a[36:39], v[68:71]
    ds_read_b128 a[28:31], v6 offset:14336
    v_mfma_f32_16x16x32_bf16 v[72:75], a[8:11], a[36:39], v[72:75]
    v_mfma_f32_16x16x32_bf16 v[76:79], a[12:15], a[36:39], v[76:79]
    v_mfma_f32_16x16x32_bf16 v[80:83], a[0:3], a[40:43], v[80:83]
    ds_read_b128 a[36:39], v2 offset:14336
    v_mfma_f32_16x16x32_bf16 v[84:87], a[4:7], a[40:43], v[84:87]
    v_mfma_f32_16x16x32_bf16 v[88:91], a[8:11], a[40:43], v[88:91]
    v_mfma_f32_16x16x32_bf16 v[92:95], a[12:15], a[40:43], v[92:95]
    s_waitcnt lgkmcnt(8)
    v_mfma_f32_16x16x32_bf16 v[96:99], a[0:3], a[44:47], v[96:99]
    ds_read_b128 a[40:43], v1 offset:16384
    v_mfma_f32_16x16x32_bf16 v[100:103], a[4:7], a[44:47], v[100:103]
    v_mfma_f32_16x16x32_bf16 v[104:107], a[8:11], a[44:47], v[104:107]
    v_mfma_f32_16x16x32_bf16 v[108:111], a[12:15], a[44:47], v[108:111]
    s_waitcnt lgkmcnt(8)
    v_mfma_f32_16x16x32_bf16 v[112:115], a[0:3], a[48:51], v[112:115]
    ds_read_b128 a[44:47], v3 offset:0
    v_mfma_f32_16x16x32_bf16 v[116:119], a[4:7], a[48:51], v[116:119]
    v_mfma_f32_16x16x32_bf16 v[120:123], a[8:11], a[48:51], v[120:123]
    v_mfma_f32_16x16x32_bf16 v[124:127], a[12:15], a[48:51], v[124:127]
    s_waitcnt lgkmcnt(8)
    v_mfma_f32_16x16x32_bf16 v[128:131], a[0:3], a[52:55], v[128:131]
    ds_read_b128 a[48:51], v3 offset:2048
    v_mfma_f32_16x16x32_bf16 v[132:135], a[4:7], a[52:55], v[132:135]
    v_mfma_f32_16x16x32_bf16 v[136:139], a[8:11], a[52:55], v[136:139]
    v_mfma_f32_16x16x32_bf16 v[140:143], a[12:15], a[52:55], v[140:143]
    s_waitcnt lgkmcnt(5)
    v_mfma_f32_16x16x32_bf16 v[144:147], a[0:3], a[32:35], v[144:147]
    ds_read_b128 a[52:55], v3 offset:4096
    v_mfma_f32_16x16x32_bf16 v[148:151], a[4:7], a[32:35], v[148:151]
    v_mfma_f32_16x16x32_bf16 v[152:155], a[8:11], a[32:35], v[152:155]
    v_mfma_f32_16x16x32_bf16 v[156:159], a[12:15], a[32:35], v[156:159]
    s_waitcnt lgkmcnt(4)
    v_mfma_f32_16x16x32_bf16 v[160:163], a[0:3], a[36:39], v[160:163]
    ds_read_b128 a[32:35], v3 offset:6144
    v_mfma_f32_16x16x32_bf16 v[164:167], a[4:7], a[36:39], v[164:167]
    v_mfma_f32_16x16x32_bf16 v[168:171], a[8:11], a[36:39], v[168:171]
    v_mfma_f32_16x16x32_bf16 v[172:175], a[12:15], a[36:39], v[172:175]
    s_waitcnt lgkmcnt(4)
    v_mfma_f32_16x16x32_bf16 v[176:179], a[0:3], a[40:43], v[176:179]
    ds_read_b128 a[36:39], v4 offset:8192
    v_mfma_f32_16x16x32_bf16 v[180:183], a[4:7], a[40:43], v[180:183]
    v_mfma_f32_16x16x32_bf16 v[184:187], a[8:11], a[40:43], v[184:187]
    v_mfma_f32_16x16x32_bf16 v[188:191], a[12:15], a[40:43], v[188:191]
    s_waitcnt lgkmcnt(4)
    v_mfma_f32_16x16x32_bf16 v[48:51], a[16:19], a[44:47], v[48:51]
    ds_read_b128 a[40:43], v4 offset:10240
    v_mfma_f32_16x16x32_bf16 v[52:55], a[20:23], a[44:47], v[52:55]
    v_mfma_f32_16x16x32_bf16 v[56:59], a[24:27], a[44:47], v[56:59]
    v_mfma_f32_16x16x32_bf16 v[60:63], a[28:31], a[44:47], v[60:63]
    s_waitcnt lgkmcnt(4)
    v_mfma_f32_16x16x32_bf16 v[64:67], a[16:19], a[48:51], v[64:67]
    ds_read_b128 a[44:47], v4 offset:12288
    v_mfma_f32_16x16x32_bf16 v[68:71], a[20:23], a[48:51], v[68:71]
    v_mfma_f32_16x16x32_bf16 v[72:75], a[24:27], a[48:51], v[72:75]
    v_mfma_f32_16x16x32_bf16 v[76:79], a[28:31], a[48:51], v[76:79]
    s_waitcnt lgkmcnt(4)
    v_mfma_f32_16x16x32_bf16 v[80:83], a[16:19], a[52:55], v[80:83]
    ds_read_b128 a[48:51], v4 offset:14336
    v_mfma_f32_16x16x32_bf16 v[84:87], a[20:23], a[52:55], v[84:87]
    v_mfma_f32_16x16x32_bf16 v[88:91], a[24:27], a[52:55], v[88:91]
    v_mfma_f32_16x16x32_bf16 v[92:95], a[28:31], a[52:55], v[92:95]
    s_waitcnt lgkmcnt(4)
    v_mfma_f32_16x16x32_bf16 v[96:99], a[16:19], a[32:35], v[96:99]
    ds_read_b128 a[52:55], v3 offset:16384
    v_mfma_f32_16x16x32_bf16 v[100:103], a[20:23], a[32:35], v[100:103]
    v_mfma_f32_16x16x32_bf16 v[104:107], a[24:27], a[32:35], v[104:107]
    v_mfma_f32_16x16x32_bf16 v[108:111], a[28:31], a[32:35], v[108:111]
    s_waitcnt lgkmcnt(4)
    v_mfma_f32_16x16x32_bf16 v[112:115], a[16:19], a[36:39], v[112:115]
    v_mfma_f32_16x16x32_bf16 v[116:119], a[20:23], a[36:39], v[116:119]
    v_mfma_f32_16x16x32_bf16 v[120:123], a[24:27], a[36:39], v[120:123]
    v_mfma_f32_16x16x32_bf16 v[124:127], a[28:31], a[36:39], v[124:127]
    s_waitcnt lgkmcnt(0)
    s_barrier
    v_mfma_f32_16x16x32_bf16 v[128:131], a[16:19], a[40:43], v[128:131]
    ds_read_b128 a[32:35], v1 offset:18432
    v_mfma_f32_16x16x32_bf16 v[132:135], a[20:23], a[40:43], v[132:135]
    ds_read_b128 a[36:39], v1 offset:20480
    v_mfma_f32_16x16x32_bf16 v[136:139], a[24:27], a[40:43], v[136:139]
    ds_read_b128 a[0:3], v5 offset:16384
    v_mfma_f32_16x16x32_bf16 v[140:143], a[28:31], a[40:43], v[140:143]
    ds_read_b128 a[4:7], v5 offset:18432
    v_mfma_f32_16x16x32_bf16 v[144:147], a[16:19], a[44:47], v[144:147]
    ds_read_b128 a[40:43], v1 offset:22528
    v_mfma_f32_16x16x32_bf16 v[148:151], a[20:23], a[44:47], v[148:151]
    ds_read_b128 a[8:11], v5 offset:20480
    v_mfma_f32_16x16x32_bf16 v[152:155], a[24:27], a[44:47], v[152:155]
    ds_read_b128 a[12:15], v5 offset:22528
    v_mfma_f32_16x16x32_bf16 v[156:159], a[28:31], a[44:47], v[156:159]
    v_mfma_f32_16x16x32_bf16 v[160:163], a[16:19], a[48:51], v[160:163]
    ds_read_b128 a[44:47], v1 offset:24576
    v_mfma_f32_16x16x32_bf16 v[164:167], a[20:23], a[48:51], v[164:167]
    v_mfma_f32_16x16x32_bf16 v[168:171], a[24:27], a[48:51], v[168:171]
    v_mfma_f32_16x16x32_bf16 v[172:175], a[28:31], a[48:51], v[172:175]
    v_mfma_f32_16x16x32_bf16 v[176:179], a[16:19], a[52:55], v[176:179]
    ds_read_b128 a[48:51], v2 offset:26624
    v_mfma_f32_16x16x32_bf16 v[180:183], a[20:23], a[52:55], v[180:183]
    v_mfma_f32_16x16x32_bf16 v[184:187], a[24:27], a[52:55], v[184:187]
    v_mfma_f32_16x16x32_bf16 v[188:191], a[28:31], a[52:55], v[188:191]
    s_waitcnt lgkmcnt(2)
    v_mfma_f32_16x16x32_bf16 v[48:51], a[0:3], a[32:35], v[48:51]
    ds_read_b128 a[52:55], v2 offset:28672
    v_mfma_f32_16x16x32_bf16 v[52:55], a[4:7], a[32:35], v[52:55]
    ds_read_b128 a[16:19], v6 offset:16384
    v_mfma_f32_16x16x32_bf16 v[56:59], a[8:11], a[32:35], v[56:59]
    ds_read_b128 a[20:23], v6 offset:18432
    v_mfma_f32_16x16x32_bf16 v[60:63], a[12:15], a[32:35], v[60:63]
    ds_read_b128 a[24:27], v6 offset:20480
    v_mfma_f32_16x16x32_bf16 v[64:67], a[0:3], a[36:39], v[64:67]
    ds_read_b128 a[32:35], v2 offset:30720
    v_mfma_f32_16x16x32_bf16 v[68:71], a[4:7], a[36:39], v[68:71]
    ds_read_b128 a[28:31], v6 offset:22528
    v_mfma_f32_16x16x32_bf16 v[72:75], a[8:11], a[36:39], v[72:75]
    v_mfma_f32_16x16x32_bf16 v[76:79], a[12:15], a[36:39], v[76:79]
    v_mfma_f32_16x16x32_bf16 v[80:83], a[0:3], a[40:43], v[80:83]
    ds_read_b128 a[36:39], v2 offset:32768
    v_mfma_f32_16x16x32_bf16 v[84:87], a[4:7], a[40:43], v[84:87]
    v_mfma_f32_16x16x32_bf16 v[88:91], a[8:11], a[40:43], v[88:91]
    v_mfma_f32_16x16x32_bf16 v[92:95], a[12:15], a[40:43], v[92:95]
    s_waitcnt lgkmcnt(8)
    v_mfma_f32_16x16x32_bf16 v[96:99], a[0:3], a[44:47], v[96:99]
    ds_read_b128 a[40:43], v1 offset:34816
    v_mfma_f32_16x16x32_bf16 v[100:103], a[4:7], a[44:47], v[100:103]
    v_mfma_f32_16x16x32_bf16 v[104:107], a[8:11], a[44:47], v[104:107]
    v_mfma_f32_16x16x32_bf16 v[108:111], a[12:15], a[44:47], v[108:111]
    s_waitcnt lgkmcnt(8)
    v_mfma_f32_16x16x32_bf16 v[112:115], a[0:3], a[48:51], v[112:115]
    ds_read_b128 a[44:47], v3 offset:18432
    v_mfma_f32_16x16x32_bf16 v[116:119], a[4:7], a[48:51], v[116:119]
    v_mfma_f32_16x16x32_bf16 v[120:123], a[8:11], a[48:51], v[120:123]
    v_mfma_f32_16x16x32_bf16 v[124:127], a[12:15], a[48:51], v[124:127]
    s_waitcnt lgkmcnt(8)
    v_mfma_f32_16x16x32_bf16 v[128:131], a[0:3], a[52:55], v[128:131]
    ds_read_b128 a[48:51], v3 offset:20480
    v_mfma_f32_16x16x32_bf16 v[132:135], a[4:7], a[52:55], v[132:135]
    v_mfma_f32_16x16x32_bf16 v[136:139], a[8:11], a[52:55], v[136:139]
    v_mfma_f32_16x16x32_bf16 v[140:143], a[12:15], a[52:55], v[140:143]
    s_waitcnt lgkmcnt(5)
    v_mfma_f32_16x16x32_bf16 v[144:147], a[0:3], a[32:35], v[144:147]
    ds_read_b128 a[52:55], v3 offset:22528
    v_mfma_f32_16x16x32_bf16 v[148:151], a[4:7], a[32:35], v[148:151]
    v_mfma_f32_16x16x32_bf16 v[152:155], a[8:11], a[32:35], v[152:155]
    v_mfma_f32_16x16x32_bf16 v[156:159], a[12:15], a[32:35], v[156:159]
    s_waitcnt lgkmcnt(4)
    v_mfma_f32_16x16x32_bf16 v[160:163], a[0:3], a[36:39], v[160:163]
    ds_read_b128 a[32:35], v3 offset:24576
    v_mfma_f32_16x16x32_bf16 v[164:167], a[4:7], a[36:39], v[164:167]
    v_mfma_f32_16x16x32_bf16 v[168:171], a[8:11], a[36:39], v[168:171]
    v_mfma_f32_16x16x32_bf16 v[172:175], a[12:15], a[36:39], v[172:175]
    s_waitcnt lgkmcnt(4)
    v_mfma_f32_16x16x32_bf16 v[176:179], a[0:3], a[40:43], v[176:179]
    ds_read_b128 a[36:39], v4 offset:26624
    v_mfma_f32_16x16x32_bf16 v[180:183], a[4:7], a[40:43], v[180:183]
    v_mfma_f32_16x16x32_bf16 v[184:187], a[8:11], a[40:43], v[184:187]
    v_mfma_f32_16x16x32_bf16 v[188:191], a[12:15], a[40:43], v[188:191]
    s_waitcnt lgkmcnt(4)
    v_mfma_f32_16x16x32_bf16 v[48:51], a[16:19], a[44:47], v[48:51]
    ds_read_b128 a[40:43], v4 offset:28672
    v_mfma_f32_16x16x32_bf16 v[52:55], a[20:23], a[44:47], v[52:55]
    v_mfma_f32_16x16x32_bf16 v[56:59], a[24:27], a[44:47], v[56:59]
    v_mfma_f32_16x16x32_bf16 v[60:63], a[28:31], a[44:47], v[60:63]
    s_waitcnt lgkmcnt(4)
    v_mfma_f32_16x16x32_bf16 v[64:67], a[16:19], a[48:51], v[64:67]
    ds_read_b128 a[44:47], v4 offset:30720
    v_mfma_f32_16x16x32_bf16 v[68:71], a[20:23], a[48:51], v[68:71]
    v_mfma_f32_16x16x32_bf16 v[72:75], a[24:27], a[48:51], v[72:75]
    v_mfma_f32_16x16x32_bf16 v[76:79], a[28:31], a[48:51], v[76:79]
    s_waitcnt lgkmcnt(4)
    v_mfma_f32_16x16x32_bf16 v[80:83], a[16:19], a[52:55], v[80:83]
    ds_read_b128 a[48:51], v4 offset:32768
    v_mfma_f32_16x16x32_bf16 v[84:87], a[20:23], a[52:55], v[84:87]
    v_mfma_f32_16x16x32_bf16 v[88:91], a[24:27], a[52:55], v[88:91]
    v_mfma_f32_16x16x32_bf16 v[92:95], a[28:31], a[52:55], v[92:95]
    s_waitcnt lgkmcnt(4)
    v_mfma_f32_16x16x32_bf16 v[96:99], a[16:19], a[32:35], v[96:99]
    ds_read_b128 a[52:55], v3 offset:34816
    v_mfma_f32_16x16x32_bf16 v[100:103], a[20:23], a[32:35], v[100:103]
    v_mfma_f32_16x16x32_bf16 v[104:107], a[24:27], a[32:35], v[104:107]
    v_mfma_f32_16x16x32_bf16 v[108:111], a[28:31], a[32:35], v[108:111]
    s_waitcnt lgkmcnt(4)
    v_mfma_f32_16x16x32_bf16 v[112:115], a[16:19], a[36:39], v[112:115]
    v_mfma_f32_16x16x32_bf16 v[116:119], a[20:23], a[36:39], v[116:119]
    v_mfma_f32_16x16x32_bf16 v[120:123], a[24:27], a[36:39], v[120:123]
    v_mfma_f32_16x16x32_bf16 v[124:127], a[28:31], a[36:39], v[124:127]
    s_waitcnt lgkmcnt(0)
    s_barrier
    v_mfma_f32_16x16x32_bf16 v[128:131], a[16:19], a[40:43], v[128:131]
    ds_read_b128 a[32:35], v1 offset:0
    v_mfma_f32_16x16x32_bf16 v[132:135], a[20:23], a[40:43], v[132:135]
    ds_read_b128 a[36:39], v1 offset:2048
    v_mfma_f32_16x16x32_bf16 v[136:139], a[24:27], a[40:43], v[136:139]
    ds_read_b128 a[0:3], v5 offset:0
    v_mfma_f32_16x16x32_bf16 v[140:143], a[28:31], a[40:43], v[140:143]
    ds_read_b128 a[4:7], v5 offset:2048
    v_mfma_f32_16x16x32_bf16 v[144:147], a[16:19], a[44:47], v[144:147]
    ds_read_b128 a[40:43], v1 offset:4096
    v_mfma_f32_16x16x32_bf16 v[148:151], a[20:23], a[44:47], v[148:151]
    ds_read_b128 a[8:11], v5 offset:4096
    v_mfma_f32_16x16x32_bf16 v[152:155], a[24:27], a[44:47], v[152:155]
    ds_read_b128 a[12:15], v5 offset:6144
    v_mfma_f32_16x16x32_bf16 v[156:159], a[28:31], a[44:47], v[156:159]
    v_mfma_f32_16x16x32_bf16 v[160:163], a[16:19], a[48:51], v[160:163]
    ds_read_b128 a[44:47], v1 offset:6144
    v_mfma_f32_16x16x32_bf16 v[164:167], a[20:23], a[48:51], v[164:167]
    v_mfma_f32_16x16x32_bf16 v[168:171], a[24:27], a[48:51], v[168:171]
    v_mfma_f32_16x16x32_bf16 v[172:175], a[28:31], a[48:51], v[172:175]
    v_mfma_f32_16x16x32_bf16 v[176:179], a[16:19], a[52:55], v[176:179]
    ds_read_b128 a[48:51], v2 offset:8192
    v_mfma_f32_16x16x32_bf16 v[180:183], a[20:23], a[52:55], v[180:183]
    v_mfma_f32_16x16x32_bf16 v[184:187], a[24:27], a[52:55], v[184:187]
    v_mfma_f32_16x16x32_bf16 v[188:191], a[28:31], a[52:55], v[188:191]
    s_waitcnt lgkmcnt(2)
    v_mfma_f32_16x16x32_bf16 v[48:51], a[0:3], a[32:35], v[48:51]
    ds_read_b128 a[52:55], v2 offset:10240
    v_mfma_f32_16x16x32_bf16 v[52:55], a[4:7], a[32:35], v[52:55]
    ds_read_b128 a[16:19], v6 offset:0
    v_mfma_f32_16x16x32_bf16 v[56:59], a[8:11], a[32:35], v[56:59]
    ds_read_b128 a[20:23], v6 offset:2048
    v_mfma_f32_16x16x32_bf16 v[60:63], a[12:15], a[32:35], v[60:63]
    ds_read_b128 a[24:27], v6 offset:4096
    v_mfma_f32_16x16x32_bf16 v[64:67], a[0:3], a[36:39], v[64:67]
    ds_read_b128 a[32:35], v2 offset:12288
    v_mfma_f32_16x16x32_bf16 v[68:71], a[4:7], a[36:39], v[68:71]
    ds_read_b128 a[28:31], v6 offset:6144
    v_mfma_f32_16x16x32_bf16 v[72:75], a[8:11], a[36:39], v[72:75]
    v_mfma_f32_16x16x32_bf16 v[76:79], a[12:15], a[36:39], v[76:79]
    v_mfma_f32_16x16x32_bf16 v[80:83], a[0:3], a[40:43], v[80:83]
    ds_read_b128 a[36:39], v2 offset:14336
    v_mfma_f32_16x16x32_bf16 v[84:87], a[4:7], a[40:43], v[84:87]
    v_mfma_f32_16x16x32_bf16 v[88:91], a[8:11], a[40:43], v[88:91]
    v_mfma_f32_16x16x32_bf16 v[92:95], a[12:15], a[40:43], v[92:95]
    s_waitcnt lgkmcnt(8)
    v_mfma_f32_16x16x32_bf16 v[96:99], a[0:3], a[44:47], v[96:99]
    ds_read_b128 a[40:43], v1 offset:16384
    v_mfma_f32_16x16x32_bf16 v[100:103], a[4:7], a[44:47], v[100:103]
    v_mfma_f32_16x16x32_bf16 v[104:107], a[8:11], a[44:47], v[104:107]
    v_mfma_f32_16x16x32_bf16 v[108:111], a[12:15], a[44:47], v[108:111]
    s_waitcnt lgkmcnt(8)
    v_mfma_f32_16x16x32_bf16 v[112:115], a[0:3], a[48:51], v[112:115]
    ds_read_b128 a[44:47], v3 offset:0
    v_mfma_f32_16x16x32_bf16 v[116:119], a[4:7], a[48:51], v[116:119]
    v_mfma_f32_16x16x32_bf16 v[120:123], a[8:11], a[48:51], v[120:123]
    v_mfma_f32_16x16x32_bf16 v[124:127], a[12:15], a[48:51], v[124:127]
    s_waitcnt lgkmcnt(8)
    v_mfma_f32_16x16x32_bf16 v[128:131], a[0:3], a[52:55], v[128:131]
    ds_read_b128 a[48:51], v3 offset:2048
    v_mfma_f32_16x16x32_bf16 v[132:135], a[4:7], a[52:55], v[132:135]
    v_mfma_f32_16x16x32_bf16 v[136:139], a[8:11], a[52:55], v[136:139]
    v_mfma_f32_16x16x32_bf16 v[140:143], a[12:15], a[52:55], v[140:143]
    s_waitcnt lgkmcnt(5)
    v_mfma_f32_16x16x32_bf16 v[144:147], a[0:3], a[32:35], v[144:147]
    ds_read_b128 a[52:55], v3 offset:4096
    v_mfma_f32_16x16x32_bf16 v[148:151], a[4:7], a[32:35], v[148:151]
    v_mfma_f32_16x16x32_bf16 v[152:155], a[8:11], a[32:35], v[152:155]
    v_mfma_f32_16x16x32_bf16 v[156:159], a[12:15], a[32:35], v[156:159]
    s_waitcnt lgkmcnt(4)
    v_mfma_f32_16x16x32_bf16 v[160:163], a[0:3], a[36:39], v[160:163]
    ds_read_b128 a[32:35], v3 offset:6144
    v_mfma_f32_16x16x32_bf16 v[164:167], a[4:7], a[36:39], v[164:167]
    v_mfma_f32_16x16x32_bf16 v[168:171], a[8:11], a[36:39], v[168:171]
    v_mfma_f32_16x16x32_bf16 v[172:175], a[12:15], a[36:39], v[172:175]
    s_waitcnt lgkmcnt(4)
    v_mfma_f32_16x16x32_bf16 v[176:179], a[0:3], a[40:43], v[176:179]
    ds_read_b128 a[36:39], v4 offset:8192
    v_mfma_f32_16x16x32_bf16 v[180:183], a[4:7], a[40:43], v[180:183]
    v_mfma_f32_16x16x32_bf16 v[184:187], a[8:11], a[40:43], v[184:187]
    v_mfma_f32_16x16x32_bf16 v[188:191], a[12:15], a[40:43], v[188:191]
    s_waitcnt lgkmcnt(4)
    v_mfma_f32_16x16x32_bf16 v[48:51], a[16:19], a[44:47], v[48:51]
    ds_read_b128 a[40:43], v4 offset:10240
    v_mfma_f32_16x16x32_bf16 v[52:55], a[20:23], a[44:47], v[52:55]
    v_mfma_f32_16x16x32_bf16 v[56:59], a[24:27], a[44:47], v[56:59]
    v_mfma_f32_16x16x32_bf16 v[60:63], a[28:31], a[44:47], v[60:63]
    s_waitcnt lgkmcnt(4)
    v_mfma_f32_16x16x32_bf16 v[64:67], a[16:19], a[48:51], v[64:67]
    ds_read_b128 a[44:47], v4 offset:12288
    v_mfma_f32_16x16x32_bf16 v[68:71], a[20:23], a[48:51], v[68:71]
    v_mfma_f32_16x16x32_bf16 v[72:75], a[24:27], a[48:51], v[72:75]
    v_mfma_f32_16x16x32_bf16 v[76:79], a[28:31], a[48:51], v[76:79]
    s_waitcnt lgkmcnt(4)
    v_mfma_f32_16x16x32_bf16 v[80:83], a[16:19], a[52:55], v[80:83]
    ds_read_b128 a[48:51], v4 offset:14336
    v_mfma_f32_16x16x32_bf16 v[84:87], a[20:23], a[52:55], v[84:87]
    v_mfma_f32_16x16x32_bf16 v[88:91], a[24:27], a[52:55], v[88:91]
    v_mfma_f32_16x16x32_bf16 v[92:95], a[28:31], a[52:55], v[92:95]
    s_waitcnt lgkmcnt(4)
    v_mfma_f32_16x16x32_bf16 v[96:99], a[16:19], a[32:35], v[96:99]
    ds_read_b128 a[52:55], v3 offset:16384
    v_mfma_f32_16x16x32_bf16 v[100:103], a[20:23], a[32:35], v[100:103]
    v_mfma_f32_16x16x32_bf16 v[104:107], a[24:27], a[32:35], v[104:107]
    v_mfma_f32_16x16x32_bf16 v[108:111], a[28:31], a[32:35], v[108:111]
    s_waitcnt lgkmcnt(4)
    v_mfma_f32_16x16x32_bf16 v[112:115], a[16:19], a[36:39], v[112:115]
    v_mfma_f32_16x16x32_bf16 v[116:119], a[20:23], a[36:39], v[116:119]
    v_mfma_f32_16x16x32_bf16 v[120:123], a[24:27], a[36:39], v[120:123]
    v_mfma_f32_16x16x32_bf16 v[124:127], a[28:31], a[36:39], v[124:127]
    s_waitcnt lgkmcnt(0)
    s_barrier
    v_mfma_f32_16x16x32_bf16 v[128:131], a[16:19], a[40:43], v[128:131]
    ds_read_b128 a[32:35], v1 offset:18432
    v_mfma_f32_16x16x32_bf16 v[132:135], a[20:23], a[40:43], v[132:135]
    ds_read_b128 a[36:39], v1 offset:20480
    v_mfma_f32_16x16x32_bf16 v[136:139], a[24:27], a[40:43], v[136:139]
    ds_read_b128 a[0:3], v5 offset:8192
    v_mfma_f32_16x16x32_bf16 v[140:143], a[28:31], a[40:43], v[140:143]
    ds_read_b128 a[4:7], v5 offset:10240
    v_mfma_f32_16x16x32_bf16 v[144:147], a[16:19], a[44:47], v[144:147]
    ds_read_b128 a[40:43], v1 offset:22528
    v_mfma_f32_16x16x32_bf16 v[148:151], a[20:23], a[44:47], v[148:151]
    ds_read_b128 a[8:11], v5 offset:12288
    v_mfma_f32_16x16x32_bf16 v[152:155], a[24:27], a[44:47], v[152:155]
    ds_read_b128 a[12:15], v5 offset:14336
    v_mfma_f32_16x16x32_bf16 v[156:159], a[28:31], a[44:47], v[156:159]
    v_mfma_f32_16x16x32_bf16 v[160:163], a[16:19], a[48:51], v[160:163]
    ds_read_b128 a[44:47], v1 offset:24576
    v_mfma_f32_16x16x32_bf16 v[164:167], a[20:23], a[48:51], v[164:167]
    v_mfma_f32_16x16x32_bf16 v[168:171], a[24:27], a[48:51], v[168:171]
    v_mfma_f32_16x16x32_bf16 v[172:175], a[28:31], a[48:51], v[172:175]
    v_mfma_f32_16x16x32_bf16 v[176:179], a[16:19], a[52:55], v[176:179]
    ds_read_b128 a[48:51], v2 offset:26624
    v_mfma_f32_16x16x32_bf16 v[180:183], a[20:23], a[52:55], v[180:183]
    v_mfma_f32_16x16x32_bf16 v[184:187], a[24:27], a[52:55], v[184:187]
    v_mfma_f32_16x16x32_bf16 v[188:191], a[28:31], a[52:55], v[188:191]
    s_waitcnt lgkmcnt(2)
    v_mfma_f32_16x16x32_bf16 v[48:51], a[0:3], a[32:35], v[48:51]
    ds_read_b128 a[52:55], v2 offset:28672
    v_mfma_f32_16x16x32_bf16 v[52:55], a[4:7], a[32:35], v[52:55]
    ds_read_b128 a[16:19], v6 offset:8192
    v_mfma_f32_16x16x32_bf16 v[56:59], a[8:11], a[32:35], v[56:59]
    ds_read_b128 a[20:23], v6 offset:10240
    v_mfma_f32_16x16x32_bf16 v[60:63], a[12:15], a[32:35], v[60:63]
    ds_read_b128 a[24:27], v6 offset:12288
    v_mfma_f32_16x16x32_bf16 v[64:67], a[0:3], a[36:39], v[64:67]
    ds_read_b128 a[32:35], v2 offset:30720
    v_mfma_f32_16x16x32_bf16 v[68:71], a[4:7], a[36:39], v[68:71]
    ds_read_b128 a[28:31], v6 offset:14336
    v_mfma_f32_16x16x32_bf16 v[72:75], a[8:11], a[36:39], v[72:75]
    v_mfma_f32_16x16x32_bf16 v[76:79], a[12:15], a[36:39], v[76:79]
    v_mfma_f32_16x16x32_bf16 v[80:83], a[0:3], a[40:43], v[80:83]
    ds_read_b128 a[36:39], v2 offset:32768
    v_mfma_f32_16x16x32_bf16 v[84:87], a[4:7], a[40:43], v[84:87]
    v_mfma_f32_16x16x32_bf16 v[88:91], a[8:11], a[40:43], v[88:91]
    v_mfma_f32_16x16x32_bf16 v[92:95], a[12:15], a[40:43], v[92:95]
    s_waitcnt lgkmcnt(8)
    v_mfma_f32_16x16x32_bf16 v[96:99], a[0:3], a[44:47], v[96:99]
    ds_read_b128 a[40:43], v1 offset:34816
    v_mfma_f32_16x16x32_bf16 v[100:103], a[4:7], a[44:47], v[100:103]
    v_mfma_f32_16x16x32_bf16 v[104:107], a[8:11], a[44:47], v[104:107]
    v_mfma_f32_16x16x32_bf16 v[108:111], a[12:15], a[44:47], v[108:111]
    s_waitcnt lgkmcnt(8)
    v_mfma_f32_16x16x32_bf16 v[112:115], a[0:3], a[48:51], v[112:115]
    ds_read_b128 a[44:47], v3 offset:18432
    v_mfma_f32_16x16x32_bf16 v[116:119], a[4:7], a[48:51], v[116:119]
    v_mfma_f32_16x16x32_bf16 v[120:123], a[8:11], a[48:51], v[120:123]
    v_mfma_f32_16x16x32_bf16 v[124:127], a[12:15], a[48:51], v[124:127]
    s_waitcnt lgkmcnt(8)
    v_mfma_f32_16x16x32_bf16 v[128:131], a[0:3], a[52:55], v[128:131]
    ds_read_b128 a[48:51], v3 offset:20480
    v_mfma_f32_16x16x32_bf16 v[132:135], a[4:7], a[52:55], v[132:135]
    v_mfma_f32_16x16x32_bf16 v[136:139], a[8:11], a[52:55], v[136:139]
    v_mfma_f32_16x16x32_bf16 v[140:143], a[12:15], a[52:55], v[140:143]
    s_waitcnt lgkmcnt(5)
    v_mfma_f32_16x16x32_bf16 v[144:147], a[0:3], a[32:35], v[144:147]
    ds_read_b128 a[52:55], v3 offset:22528
    v_mfma_f32_16x16x32_bf16 v[148:151], a[4:7], a[32:35], v[148:151]
    v_mfma_f32_16x16x32_bf16 v[152:155], a[8:11], a[32:35], v[152:155]
    v_mfma_f32_16x16x32_bf16 v[156:159], a[12:15], a[32:35], v[156:159]
    s_waitcnt lgkmcnt(4)
    v_mfma_f32_16x16x32_bf16 v[160:163], a[0:3], a[36:39], v[160:163]
    ds_read_b128 a[32:35], v3 offset:24576
    v_mfma_f32_16x16x32_bf16 v[164:167], a[4:7], a[36:39], v[164:167]
    v_mfma_f32_16x16x32_bf16 v[168:171], a[8:11], a[36:39], v[168:171]
    v_mfma_f32_16x16x32_bf16 v[172:175], a[12:15], a[36:39], v[172:175]
    s_waitcnt lgkmcnt(4)
    v_mfma_f32_16x16x32_bf16 v[176:179], a[0:3], a[40:43], v[176:179]
    ds_read_b128 a[36:39], v4 offset:26624
    v_mfma_f32_16x16x32_bf16 v[180:183], a[4:7], a[40:43], v[180:183]
    v_mfma_f32_16x16x32_bf16 v[184:187], a[8:11], a[40:43], v[184:187]
    v_mfma_f32_16x16x32_bf16 v[188:191], a[12:15], a[40:43], v[188:191]
    s_waitcnt lgkmcnt(4)
    v_mfma_f32_16x16x32_bf16 v[48:51], a[16:19], a[44:47], v[48:51]
    ds_read_b128 a[40:43], v4 offset:28672
    v_mfma_f32_16x16x32_bf16 v[52:55], a[20:23], a[44:47], v[52:55]
    v_mfma_f32_16x16x32_bf16 v[56:59], a[24:27], a[44:47], v[56:59]
    v_mfma_f32_16x16x32_bf16 v[60:63], a[28:31], a[44:47], v[60:63]
    s_waitcnt lgkmcnt(4)
    v_mfma_f32_16x16x32_bf16 v[64:67], a[16:19], a[48:51], v[64:67]
    ds_read_b128 a[44:47], v4 offset:30720
    v_mfma_f32_16x16x32_bf16 v[68:71], a[20:23], a[48:51], v[68:71]
    v_mfma_f32_16x16x32_bf16 v[72:75], a[24:27], a[48:51], v[72:75]
    v_mfma_f32_16x16x32_bf16 v[76:79], a[28:31], a[48:51], v[76:79]
    s_waitcnt lgkmcnt(4)
    v_mfma_f32_16x16x32_bf16 v[80:83], a[16:19], a[52:55], v[80:83]
    ds_read_b128 a[48:51], v4 offset:32768
    v_mfma_f32_16x16x32_bf16 v[84:87], a[20:23], a[52:55], v[84:87]
    v_mfma_f32_16x16x32_bf16 v[88:91], a[24:27], a[52:55], v[88:91]
    v_mfma_f32_16x16x32_bf16 v[92:95], a[28:31], a[52:55], v[92:95]
    s_waitcnt lgkmcnt(4)
    v_mfma_f32_16x16x32_bf16 v[96:99], a[16:19], a[32:35], v[96:99]
    ds_read_b128 a[52:55], v3 offset:34816
    v_mfma_f32_16x16x32_bf16 v[100:103], a[20:23], a[32:35], v[100:103]
    v_mfma_f32_16x16x32_bf16 v[104:107], a[24:27], a[32:35], v[104:107]
    v_mfma_f32_16x16x32_bf16 v[108:111], a[28:31], a[32:35], v[108:111]
    s_waitcnt lgkmcnt(4)
    v_mfma_f32_16x16x32_bf16 v[112:115], a[16:19], a[36:39], v[112:115]
    v_mfma_f32_16x16x32_bf16 v[116:119], a[20:23], a[36:39], v[116:119]
    v_mfma_f32_16x16x32_bf16 v[120:123], a[24:27], a[36:39], v[120:123]
    v_mfma_f32_16x16x32_bf16 v[124:127], a[28:31], a[36:39], v[124:127]
    s_waitcnt lgkmcnt(0)
    s_barrier
    v_mfma_f32_16x16x32_bf16 v[128:131], a[16:19], a[40:43], v[128:131]
    ds_read_b128 a[32:35], v1 offset:0
    v_mfma_f32_16x16x32_bf16 v[132:135], a[20:23], a[40:43], v[132:135]
    ds_read_b128 a[36:39], v1 offset:2048
    v_mfma_f32_16x16x32_bf16 v[136:139], a[24:27], a[40:43], v[136:139]
    ds_read_b128 a[0:3], v5 offset:16384
    v_mfma_f32_16x16x32_bf16 v[140:143], a[28:31], a[40:43], v[140:143]
    ds_read_b128 a[4:7], v5 offset:18432
    v_mfma_f32_16x16x32_bf16 v[144:147], a[16:19], a[44:47], v[144:147]
    ds_read_b128 a[40:43], v1 offset:4096
    v_mfma_f32_16x16x32_bf16 v[148:151], a[20:23], a[44:47], v[148:151]
    ds_read_b128 a[8:11], v5 offset:20480
    v_mfma_f32_16x16x32_bf16 v[152:155], a[24:27], a[44:47], v[152:155]
    ds_read_b128 a[12:15], v5 offset:22528
    v_mfma_f32_16x16x32_bf16 v[156:159], a[28:31], a[44:47], v[156:159]
    v_mfma_f32_16x16x32_bf16 v[160:163], a[16:19], a[48:51], v[160:163]
    ds_read_b128 a[44:47], v1 offset:6144
    v_mfma_f32_16x16x32_bf16 v[164:167], a[20:23], a[48:51], v[164:167]
    v_mfma_f32_16x16x32_bf16 v[168:171], a[24:27], a[48:51], v[168:171]
    v_mfma_f32_16x16x32_bf16 v[172:175], a[28:31], a[48:51], v[172:175]
    v_mfma_f32_16x16x32_bf16 v[176:179], a[16:19], a[52:55], v[176:179]
    ds_read_b128 a[48:51], v2 offset:8192
    v_mfma_f32_16x16x32_bf16 v[180:183], a[20:23], a[52:55], v[180:183]
    v_mfma_f32_16x16x32_bf16 v[184:187], a[24:27], a[52:55], v[184:187]
    v_mfma_f32_16x16x32_bf16 v[188:191], a[28:31], a[52:55], v[188:191]
    s_waitcnt lgkmcnt(2)
    v_mfma_f32_16x16x32_bf16 v[48:51], a[0:3], a[32:35], v[48:51]
    ds_read_b128 a[52:55], v2 offset:10240
    v_mfma_f32_16x16x32_bf16 v[52:55], a[4:7], a[32:35], v[52:55]
    ds_read_b128 a[16:19], v6 offset:16384
    v_mfma_f32_16x16x32_bf16 v[64:67], a[0:3], a[36:39], v[64:67]
    ds_read_b128 a[32:35], v2 offset:12288
    v_mfma_f32_16x16x32_bf16 v[68:71], a[4:7], a[36:39], v[68:71]
    ds_read_b128 a[20:23], v6 offset:18432
    v_mfma_f32_16x16x32_bf16 v[80:83], a[0:3], a[40:43], v[80:83]
    ds_read_b128 a[36:39], v2 offset:14336
    v_mfma_f32_16x16x32_bf16 v[84:87], a[4:7], a[40:43], v[84:87]
    ds_read_b128 a[24:27], v6 offset:20480
    s_waitcnt lgkmcnt(7)
    v_mfma_f32_16x16x32_bf16 v[96:99], a[0:3], a[44:47], v[96:99]
    ds_read_b128 a[40:43], v1 offset:16384
    v_mfma_f32_16x16x32_bf16 v[100:103], a[4:7], a[44:47], v[100:103]
    ds_read_b128 a[28:31], v6 offset:22528
    s_waitcnt lgkmcnt(8)
    v_mfma_f32_16x16x32_bf16 v[112:115], a[0:3], a[48:51], v[112:115]
    ds_read_b128 a[44:47], v3 offset:0
    v_mfma_f32_16x16x32_bf16 v[116:119], a[4:7], a[48:51], v[116:119]
    s_waitcnt lgkmcnt(8)
    v_mfma_f32_16x16x32_bf16 v[128:131], a[0:3], a[52:55], v[128:131]
    ds_read_b128 a[48:51], v3 offset:2048
    v_mfma_f32_16x16x32_bf16 v[132:135], a[4:7], a[52:55], v[132:135]
    s_waitcnt lgkmcnt(7)
    v_mfma_f32_16x16x32_bf16 v[144:147], a[0:3], a[32:35], v[144:147]
    ds_read_b128 a[52:55], v3 offset:4096
    v_mfma_f32_16x16x32_bf16 v[148:151], a[4:7], a[32:35], v[148:151]
    s_waitcnt lgkmcnt(6)
    v_mfma_f32_16x16x32_bf16 v[160:163], a[0:3], a[36:39], v[160:163]
    ds_read_b128 a[32:35], v3 offset:6144
    v_mfma_f32_16x16x32_bf16 v[164:167], a[4:7], a[36:39], v[164:167]
    s_waitcnt lgkmcnt(5)
    v_mfma_f32_16x16x32_bf16 v[176:179], a[0:3], a[40:43], v[176:179]
    ds_read_b128 a[36:39], v4 offset:8192
    v_mfma_f32_16x16x32_bf16 v[180:183], a[4:7], a[40:43], v[180:183]
    s_waitcnt lgkmcnt(4)
    v_mfma_f32_16x16x32_bf16 v[48:51], a[16:19], a[44:47], v[48:51]
    ds_read_b128 a[40:43], v4 offset:10240
    v_mfma_f32_16x16x32_bf16 v[52:55], a[20:23], a[44:47], v[52:55]
    s_waitcnt lgkmcnt(4)
    v_mfma_f32_16x16x32_bf16 v[64:67], a[16:19], a[48:51], v[64:67]
    ds_read_b128 a[44:47], v4 offset:12288
    v_mfma_f32_16x16x32_bf16 v[68:71], a[20:23], a[48:51], v[68:71]
    s_waitcnt lgkmcnt(4)
    v_mfma_f32_16x16x32_bf16 v[80:83], a[16:19], a[52:55], v[80:83]
    ds_read_b128 a[48:51], v4 offset:14336
    v_mfma_f32_16x16x32_bf16 v[84:87], a[20:23], a[52:55], v[84:87]
    s_waitcnt lgkmcnt(4)
    v_mfma_f32_16x16x32_bf16 v[96:99], a[16:19], a[32:35], v[96:99]
    ds_read_b128 a[52:55], v3 offset:16384
    v_mfma_f32_16x16x32_bf16 v[100:103], a[20:23], a[32:35], v[100:103]
    s_waitcnt lgkmcnt(4)
    v_mfma_f32_16x16x32_bf16 v[112:115], a[16:19], a[36:39], v[112:115]
    ds_read_b128 a[32:35], v1 offset:0
    v_mfma_f32_16x16x32_bf16 v[116:119], a[20:23], a[36:39], v[116:119]
    s_waitcnt lgkmcnt(4)
    v_mfma_f32_16x16x32_bf16 v[128:131], a[16:19], a[40:43], v[128:131]
    ds_read_b128 a[36:39], v1 offset:2048
    v_mfma_f32_16x16x32_bf16 v[132:135], a[20:23], a[40:43], v[132:135]
    s_waitcnt lgkmcnt(4)
    v_mfma_f32_16x16x32_bf16 v[144:147], a[16:19], a[44:47], v[144:147]
    ds_read_b128 a[40:43], v1 offset:4096
    v_mfma_f32_16x16x32_bf16 v[148:151], a[20:23], a[44:47], v[148:151]
    s_waitcnt lgkmcnt(4)
    v_mfma_f32_16x16x32_bf16 v[160:163], a[16:19], a[48:51], v[160:163]
    ds_read_b128 a[44:47], v1 offset:6144
    v_mfma_f32_16x16x32_bf16 v[164:167], a[20:23], a[48:51], v[164:167]
    s_waitcnt lgkmcnt(4)
    v_mfma_f32_16x16x32_bf16 v[176:179], a[16:19], a[52:55], v[176:179]
    ds_read_b128 a[48:51], v2 offset:8192
    v_mfma_f32_16x16x32_bf16 v[180:183], a[20:23], a[52:55], v[180:183]
    s_waitcnt lgkmcnt(4)
    v_mfma_f32_16x16x32_bf16 v[56:59], a[8:11], a[32:35], v[56:59]
    ds_read_b128 a[52:55], v2 offset:10240
    v_mfma_f32_16x16x32_bf16 v[60:63], a[12:15], a[32:35], v[60:63]
    s_waitcnt lgkmcnt(4)
    v_mfma_f32_16x16x32_bf16 v[72:75], a[8:11], a[36:39], v[72:75]
    ds_read_b128 a[32:35], v2 offset:12288
    v_mfma_f32_16x16x32_bf16 v[76:79], a[12:15], a[36:39], v[76:79]
    s_waitcnt lgkmcnt(4)
    v_mfma_f32_16x16x32_bf16 v[88:91], a[8:11], a[40:43], v[88:91]
    ds_read_b128 a[36:39], v2 offset:14336
    v_mfma_f32_16x16x32_bf16 v[92:95], a[12:15], a[40:43], v[92:95]
    s_waitcnt lgkmcnt(4)
    v_mfma_f32_16x16x32_bf16 v[104:107], a[8:11], a[44:47], v[104:107]
    ds_read_b128 a[40:43], v1 offset:16384
    v_cvt_pk_bf16_f32 v12, v48, v64
    v_mfma_f32_16x16x32_bf16 v[108:111], a[12:15], a[44:47], v[108:111]
    v_cvt_pk_bf16_f32 v13, v80, v96
    v_cvt_pk_bf16_f32 v14, v112, v128
    s_waitcnt lgkmcnt(4)
    v_mfma_f32_16x16x32_bf16 v[120:123], a[8:11], a[48:51], v[120:123]
    ds_read_b128 a[44:47], v3 offset:0
    v_cvt_pk_bf16_f32 v15, v144, v160
    s_add_u32 s58, s48, 0
    v_mfma_f32_16x16x32_bf16 v[124:127], a[12:15], a[48:51], v[124:127]
    buffer_store_dwordx4 v[12:15], v7, s[32:35], s58 offen
    v_cvt_pk_bf16_f32 v16, v49, v65
    s_waitcnt lgkmcnt(4)
    v_mfma_f32_16x16x32_bf16 v[136:139], a[8:11], a[52:55], v[136:139]
    ds_read_b128 a[48:51], v3 offset:2048
    v_cvt_pk_bf16_f32 v17, v81, v97
    v_mfma_f32_16x16x32_bf16 v[140:143], a[12:15], a[52:55], v[140:143]
    v_cvt_pk_bf16_f32 v18, v113, v129
    v_cvt_pk_bf16_f32 v19, v145, v161
    s_add_u32 s58, s48, 9216
    s_waitcnt lgkmcnt(4)
    v_mfma_f32_16x16x32_bf16 v[152:155], a[8:11], a[32:35], v[152:155]
    ds_read_b128 a[52:55], v3 offset:4096
    buffer_store_dwordx4 v[16:19], v7, s[32:35], s58 offen
    v_mfma_f32_16x16x32_bf16 v[156:159], a[12:15], a[32:35], v[156:159]
    v_cvt_pk_bf16_f32 v20, v50, v66
    v_cvt_pk_bf16_f32 v21, v82, v98
    s_waitcnt lgkmcnt(4)
    v_mfma_f32_16x16x32_bf16 v[168:171], a[8:11], a[36:39], v[168:171]
    ds_read_b128 a[32:35], v3 offset:6144
    v_cvt_pk_bf16_f32 v22, v114, v130
    v_mfma_f32_16x16x32_bf16 v[172:175], a[12:15], a[36:39], v[172:175]
    v_cvt_pk_bf16_f32 v23, v146, v162
    s_add_u32 s58, s48, 18432
    buffer_store_dwordx4 v[20:23], v7, s[32:35], s58 offen
    s_waitcnt lgkmcnt(4)
    v_mfma_f32_16x16x32_bf16 v[184:187], a[8:11], a[40:43], v[184:187]
    ds_read_b128 a[36:39], v4 offset:8192
    v_cvt_pk_bf16_f32 v24, v51, v67
    v_mfma_f32_16x16x32_bf16 v[188:191], a[12:15], a[40:43], v[188:191]
    v_cvt_pk_bf16_f32 v25, v83, v99
    v_cvt_pk_bf16_f32 v26, v115, v131
    s_waitcnt lgkmcnt(4)
    v_mfma_f32_16x16x32_bf16 v[56:59], a[24:27], a[44:47], v[56:59]
    ds_read_b128 a[40:43], v4 offset:10240
    v_cvt_pk_bf16_f32 v27, v147, v163
    s_add_u32 s58, s48, 27648
    v_mfma_f32_16x16x32_bf16 v[60:63], a[28:31], a[44:47], v[60:63]
    buffer_store_dwordx4 v[24:27], v7, s[32:35], s58 offen
    v_cvt_pk_bf16_f32 v36, v176, v177
    s_add_u32 s58, s48, 0
    s_waitcnt lgkmcnt(4)
    v_mfma_f32_16x16x32_bf16 v[72:75], a[24:27], a[48:51], v[72:75]
    ds_read_b128 a[44:47], v4 offset:12288
    buffer_store_short v36, v8, s[32:35], s58 offen offset:256
    s_add_u32 s58, s48, 9216
    v_mfma_f32_16x16x32_bf16 v[76:79], a[28:31], a[48:51], v[76:79]
    buffer_store_short_d16_hi v36, v8, s[32:35], s58 offen offset:256
    v_cvt_pk_bf16_f32 v37, v178, v179
    s_add_u32 s58, s48, 18432
    s_waitcnt lgkmcnt(4)
    v_mfma_f32_16x16x32_bf16 v[88:91], a[24:27], a[52:55], v[88:91]
    ds_read_b128 a[48:51], v4 offset:14336
    buffer_store_short v37, v8, s[32:35], s58 offen offset:256
    s_add_u32 s58, s48, 27648
    v_mfma_f32_16x16x32_bf16 v[92:95], a[28:31], a[52:55], v[92:95]
    buffer_store_short_d16_hi v37, v8, s[32:35], s58 offen offset:256
    v_cvt_pk_bf16_f32 v12, v52, v68
    s_waitcnt lgkmcnt(4)
    v_mfma_f32_16x16x32_bf16 v[104:107], a[24:27], a[32:35], v[104:107]
    ds_read_b128 a[52:55], v3 offset:16384
    v_cvt_pk_bf16_f32 v13, v84, v100
    v_mfma_f32_16x16x32_bf16 v[108:111], a[28:31], a[32:35], v[108:111]
    v_cvt_pk_bf16_f32 v14, v116, v132
    v_cvt_pk_bf16_f32 v15, v148, v164
    s_add_u32 s58, s48, 147456
    s_waitcnt lgkmcnt(4)
    v_mfma_f32_16x16x32_bf16 v[120:123], a[24:27], a[36:39], v[120:123]
    buffer_store_dwordx4 v[12:15], v7, s[32:35], s58 offen
    v_cvt_pk_bf16_f32 v16, v53, v69
    v_mfma_f32_16x16x32_bf16 v[124:127], a[28:31], a[36:39], v[124:127]
    v_cvt_pk_bf16_f32 v17, v85, v101
    v_cvt_pk_bf16_f32 v18, v117, v133
    s_waitcnt lgkmcnt(3)
    v_mfma_f32_16x16x32_bf16 v[136:139], a[24:27], a[40:43], v[136:139]
    v_cvt_pk_bf16_f32 v19, v149, v165
    s_add_u32 s58, s48, 156672
    buffer_store_dwordx4 v[16:19], v7, s[32:35], s58 offen
    v_mfma_f32_16x16x32_bf16 v[140:143], a[28:31], a[40:43], v[140:143]
    v_cvt_pk_bf16_f32 v20, v54, v70
    v_cvt_pk_bf16_f32 v21, v86, v102
    s_waitcnt lgkmcnt(2)
    v_mfma_f32_16x16x32_bf16 v[152:155], a[24:27], a[44:47], v[152:155]
    v_cvt_pk_bf16_f32 v22, v118, v134
    v_cvt_pk_bf16_f32 v23, v150, v166
    s_add_u32 s58, s48, 165888
    v_mfma_f32_16x16x32_bf16 v[156:159], a[28:31], a[44:47], v[156:159]
    buffer_store_dwordx4 v[20:23], v7, s[32:35], s58 offen
    v_cvt_pk_bf16_f32 v24, v55, v71
    s_waitcnt lgkmcnt(1)
    v_mfma_f32_16x16x32_bf16 v[168:171], a[24:27], a[48:51], v[168:171]
    v_cvt_pk_bf16_f32 v25, v87, v103
    v_cvt_pk_bf16_f32 v26, v119, v135
    v_mfma_f32_16x16x32_bf16 v[172:175], a[28:31], a[48:51], v[172:175]
    v_cvt_pk_bf16_f32 v27, v151, v167
    s_add_u32 s58, s48, 175104
    buffer_store_dwordx4 v[24:27], v7, s[32:35], s58 offen
    s_waitcnt lgkmcnt(0)
    v_mfma_f32_16x16x32_bf16 v[184:187], a[24:27], a[52:55], v[184:187]
    v_cvt_pk_bf16_f32 v38, v180, v181
    s_add_u32 s58, s48, 147456
    buffer_store_short v38, v8, s[32:35], s58 offen offset:256
    s_add_u32 s58, s48, 156672
    v_mfma_f32_16x16x32_bf16 v[188:191], a[28:31], a[52:55], v[188:191]
    buffer_store_short_d16_hi v38, v8, s[32:35], s58 offen offset:256
    v_cvt_pk_bf16_f32 v39, v182, v183
    s_add_u32 s58, s48, 165888
    buffer_store_short v39, v8, s[32:35], s58 offen offset:256
    s_add_u32 s58, s48, 175104
    buffer_store_short_d16_hi v39, v8, s[32:35], s58 offen offset:256
    s_nop 7
    s_nop 1
    v_cvt_pk_bf16_f32 v12, v56, v72
    v_cvt_pk_bf16_f32 v13, v88, v104
    v_cvt_pk_bf16_f32 v14, v120, v136
    v_cvt_pk_bf16_f32 v15, v152, v168
    s_add_u32 s58, s48, 294912
    buffer_store_dwordx4 v[12:15], v7, s[32:35], s58 offen
    v_cvt_pk_bf16_f32 v16, v57, v73
    v_cvt_pk_bf16_f32 v17, v89, v105
    v_cvt_pk_bf16_f32 v18, v121, v137
    v_cvt_pk_bf16_f32 v19, v153, v169
    s_add_u32 s58, s48, 304128
    buffer_store_dwordx4 v[16:19], v7, s[32:35], s58 offen
    v_cvt_pk_bf16_f32 v20, v58, v74
    v_cvt_pk_bf16_f32 v21, v90, v106
    v_cvt_pk_bf16_f32 v22, v122, v138
    v_cvt_pk_bf16_f32 v23, v154, v170
    s_add_u32 s58, s48, 313344
    buffer_store_dwordx4 v[20:23], v7, s[32:35], s58 offen
    v_cvt_pk_bf16_f32 v24, v59, v75
    v_cvt_pk_bf16_f32 v25, v91, v107
    v_cvt_pk_bf16_f32 v26, v123, v139
    v_cvt_pk_bf16_f32 v27, v155, v171
    s_add_u32 s58, s48, 322560
    buffer_store_dwordx4 v[24:27], v7, s[32:35], s58 offen
    v_cvt_pk_bf16_f32 v36, v184, v185
    s_add_u32 s58, s48, 294912
    buffer_store_short v36, v8, s[32:35], s58 offen offset:256
    s_add_u32 s58, s48, 304128
    buffer_store_short_d16_hi v36, v8, s[32:35], s58 offen offset:256
    v_cvt_pk_bf16_f32 v37, v186, v187
    s_add_u32 s58, s48, 313344
    buffer_store_short v37, v8, s[32:35], s58 offen offset:256
    s_add_u32 s58, s48, 322560
    buffer_store_short_d16_hi v37, v8, s[32:35], s58 offen offset:256
    v_cvt_pk_bf16_f32 v12, v60, v76
    v_cvt_pk_bf16_f32 v13, v92, v108
    v_cvt_pk_bf16_f32 v14, v124, v140
    v_cvt_pk_bf16_f32 v15, v156, v172
    s_add_u32 s58, s48, 442368
    buffer_store_dwordx4 v[12:15], v7, s[32:35], s58 offen
    v_cvt_pk_bf16_f32 v16, v61, v77
    v_cvt_pk_bf16_f32 v17, v93, v109
    v_cvt_pk_bf16_f32 v18, v125, v141
    v_cvt_pk_bf16_f32 v19, v157, v173
    s_add_u32 s58, s48, 451584
    buffer_store_dwordx4 v[16:19], v7, s[32:35], s58 offen
    v_cvt_pk_bf16_f32 v20, v62, v78
    v_cvt_pk_bf16_f32 v21, v94, v110
    v_cvt_pk_bf16_f32 v22, v126, v142
    v_cvt_pk_bf16_f32 v23, v158, v174
    s_add_u32 s58, s48, 460800
    buffer_store_dwordx4 v[20:23], v7, s[32:35], s58 offen
    v_cvt_pk_bf16_f32 v24, v63, v79
    v_cvt_pk_bf16_f32 v25, v95, v111
    v_cvt_pk_bf16_f32 v26, v127, v143
    v_cvt_pk_bf16_f32 v27, v159, v175
    s_add_u32 s58, s48, 470016
    buffer_store_dwordx4 v[24:27], v7, s[32:35], s58 offen
    v_cvt_pk_bf16_f32 v38, v188, v189
    s_add_u32 s58, s48, 442368
    buffer_store_short v38, v8, s[32:35], s58 offen offset:256
    s_add_u32 s58, s48, 451584
    buffer_store_short_d16_hi v38, v8, s[32:35], s58 offen offset:256
    v_cvt_pk_bf16_f32 v39, v190, v191
    s_add_u32 s58, s48, 460800
    buffer_store_short v39, v8, s[32:35], s58 offen offset:256
    s_add_u32 s58, s48, 470016
    buffer_store_short_d16_hi v39, v8, s[32:35], s58 offen offset:256
    s_endpgm
L_helper:
    s_mul_i32 s40, s50, 1152
    s_add_u32 s41, s40, 9216
    s_add_u32 s42, s40, 18432
    s_add_u32 s43, s40, 27648
    s_add_u32 s44, s40, 36864
    s_add_u32 s45, s40, 46080
    s_add_u32 s46, s40, 55296
    s_add_u32 s47, s40, 64512
    s_mul_i32 s49, s37, 576
    s_mov_b32 s64, 0x4b800000
    v_and_b32 v13, 63, v0
    v_and_b32 v9, 255, v0
    v_lshrrev_b32 v16, 4, v9
    v_and_b32 v17, 15, v0
    v_lshrrev_b32 v14, 4, v13
    v_lshrrev_b32 v19, 3, v13
    v_mul_u32_u24 v7, 1152, v19
    v_and_b32 v19, 7, v13
    v_xor_b32 v19, v19, v14
    v_lshl_add_u32 v7, v19, 4, v7
    v_xor_b32 v8, 64, v7
    v_mul_u32_u24 v2, 73728, v16
    v_lshl_add_u32 v2, v17, 2, v2
    v_add_u32 v2, 512, v2
    v_lshrrev_b32 v20, 5, v9
    v_and_b32 v21, 31, v0
    v_mul_u32_u24 v1, 147456, v20
    v_lshl_add_u32 v1, v21, 4, v1
    s_waitcnt lgkmcnt(0)
    s_mov_b32 s16, s4
    s_and_b32 s17, s5, 0xffff
    s_mov_b32 s18, 2359296
    s_mov_b32 s19, 0x00020000
    s_mov_b32 s20, s6
    s_and_b32 s21, s7, 0xffff
    s_mov_b32 s22, 10616832
    s_mov_b32 s23, 0x00020000
    s_mov_b32 s24, s8
    s_and_b32 s25, s9, 0xffff
    s_mov_b32 s26, 82944
    s_mov_b32 s27, 0x00020000
    s_mov_b32 s28, s10
    s_and_b32 s29, s11, 0xffff
    s_mov_b32 s30, 82944
    s_mov_b32 s31, 0x00020000
    v_lshlrev_b32 v19, 3, v21
    v_lshl_add_u32 v24, v17, 1, 0
    buffer_load_dwordx2 v[56:57], v19, s[24:27], s51 offen
    buffer_load_dwordx2 v[58:59], v19, s[28:31], s51 offen
    buffer_load_ushort v60, v24, s[24:27], s51 offen offset:256
    buffer_load_ushort v61, v24, s[28:31], s51 offen offset:256
    s_add_u32 s54, s49, 0
    buffer_load_dwordx4 v[72:75], v1, s[20:23], s54 offen
    s_add_u32 s54, s49, 18432
    buffer_load_dwordx4 v[76:79], v1, s[20:23], s54 offen
    s_add_u32 s54, s49, 36864
    buffer_load_dwordx4 v[80:83], v1, s[20:23], s54 offen
    s_add_u32 s54, s49, 55296
    buffer_load_dwordx4 v[84:87], v1, s[20:23], s54 offen
    s_add_u32 s54, s49, 73728
    buffer_load_dwordx4 v[88:91], v1, s[20:23], s54 offen
    s_add_u32 s54, s49, 92160
    buffer_load_dwordx4 v[92:95], v1, s[20:23], s54 offen
    s_add_u32 s54, s49, 110592
    buffer_load_dwordx4 v[96:99], v1, s[20:23], s54 offen
    s_add_u32 s54, s49, 129024
    buffer_load_dwordx4 v[100:103], v1, s[20:23], s54 offen
    s_add_u32 s55, s49, 0
    buffer_load_dword v104, v2, s[20:23], s55 offen
    s_add_u32 s55, s49, 18432
    buffer_load_dword v105, v2, s[20:23], s55 offen
    s_add_u32 s55, s49, 36864
    buffer_load_dword v106, v2, s[20:23], s55 offen
    s_add_u32 s55, s49, 55296
    buffer_load_dword v107, v2, s[20:23], s55 offen
    s_add_u32 m0, s39, 0
    s_nop 0
    buffer_load_dwordx4 v7, s[16:19], s40 offen offset:0 lds
    s_add_u32 m0, s39, 1024
    s_nop 0
    buffer_load_dwordx4 v8, s[16:19], s41 offen offset:0 lds
    s_add_u32 m0, s39, 2048
    s_nop 0
    buffer_load_dwordx4 v7, s[16:19], s42 offen offset:0 lds
    s_add_u32 m0, s39, 3072
    s_nop 0
    buffer_load_dwordx4 v8, s[16:19], s43 offen offset:0 lds
    s_add_u32 m0, s39, 4096
    s_nop 0
    buffer_load_dwordx4 v7, s[16:19], s44 offen offset:0 lds
    s_add_u32 m0, s39, 5120
    s_nop 0
    buffer_load_dwordx4 v8, s[16:19], s45 offen offset:0 lds
    s_add_u32 m0, s39, 6144
    s_nop 0
    buffer_load_dwordx4 v7, s[16:19], s46 offen offset:0 lds
    s_add_u32 m0, s39, 7168
    s_nop 0
    buffer_load_dwordx4 v8, s[16:19], s47 offen offset:0 lds
    v_lshrrev_b32 v22, 1, v17
    v_and_b32 v19, 1, v17
    v_lshlrev_b32 v19, 2, v19
    v_xor_b32 v22, v22, v19
    v_lshrrev_b32 v19, 1, v16
    v_xor_b32 v19, v19, v22
    v_lshlrev_b32 v19, 4, v19
    v_lshl_add_u32 v4, v17, 7, v19
    v_and_b32 v19, 1, v16
    v_lshl_add_u32 v4, v19, 3, v4
    v_lshrrev_b32 v23, 1, v21
    v_lshrrev_b32 v22, 1, v23
    v_and_b32 v19, 1, v23
    v_lshlrev_b32 v19, 2, v19
    v_xor_b32 v22, v22, v19
    v_and_b32 v24, 1, v21
    v_lshlrev_b32 v19, 1, v24
    v_xor_b32 v22, v22, v19
    v_xor_b32 v22, v22, v20
    v_lshlrev_b32 v22, 4, v22
    v_lshl_add_u32 v19, v24, 6, v23
    v_lshl_add_u32 v3, v19, 7, v22
    v_lshlrev_b32 v5, 5, v21
    v_lshlrev_b32 v6, 3, v17
    s_waitcnt vmcnt(20)
    v_lshlrev_b32 v52, 16, v56
    v_lshlrev_b32 v54, 16, v58
    v_mul_f32 v28, s64, v52
    v_mul_f32_e64 v29, -v54, v52
    v_and_b32 v52, 0xffff0000, v56
    v_and_b32 v54, 0xffff0000, v58
    v_mul_f32 v30, s64, v52
    v_mul_f32_e64 v31, -v54, v52
    v_lshlrev_b32 v52, 16, v57
    v_lshlrev_b32 v54, 16, v59
    v_mul_f32 v32, s64, v52
    v_mul_f32_e64 v33, -v54, v52
    v_and_b32 v52, 0xffff0000, v57
    v_and_b32 v54, 0xffff0000, v59
    v_mul_f32 v34, s64, v52
    v_mul_f32_e64 v35, -v54, v52
    v_lshlrev_b32 v52, 16, v60
    v_lshlrev_b32 v54, 16, v61
    v_mul_f32 v36, s64, v52
    v_mul_f32_e64 v37, -v54, v52
    s_waitcnt vmcnt(8)
    s_add_u32 s54, s49, 1179648
    buffer_load_dwordx4 v[108:111], v1, s[20:23], s54 offen
    v_fma_mix_f32 v12, v72, v28, v29 op_sel_hi:[1,0,0]
    v_fma_mix_f32 v13, v76, v28, v29 op_sel_hi:[1,0,0]
    v_fma_mix_f32 v14, v80, v28, v29 op_sel_hi:[1,0,0]
    s_add_u32 s54, s49, 1198080
    buffer_load_dwordx4 v[112:115], v1, s[20:23], s54 offen
    v_fma_mix_f32 v15, v84, v28, v29 op_sel_hi:[1,0,0]
    v_fma_mix_f32 v16, v88, v28, v29 op_sel_hi:[1,0,0]
    v_fma_mix_f32 v17, v92, v28, v29 op_sel_hi:[1,0,0]
    s_add_u32 s54, s49, 1216512
    buffer_load_dwordx4 v[116:119], v1, s[20:23], s54 offen
    v_fma_mix_f32 v18, v96, v28, v29 op_sel_hi:[1,0,0]
    v_fma_mix_f32 v19, v100, v28, v29 op_sel_hi:[1,0,0]
    v_cvt_pk_bf16_f32 v12, v12, v13
    s_add_u32 s54, s49, 1234944
    buffer_load_dwordx4 v[120:123], v1, s[20:23], s54 offen
    v_cvt_pk_bf16_f32 v13, v14, v15
    v_cvt_pk_bf16_f32 v14, v16, v17
    v_cvt_pk_bf16_f32 v15, v18, v19
    s_add_u32 s54, s49, 1253376
    buffer_load_dwordx4 v[124:127], v1, s[20:23], s54 offen
    v_fma_mix_f32 v20, v73, v30, v31 op_sel_hi:[1,0,0]
    v_fma_mix_f32 v21, v77, v30, v31 op_sel_hi:[1,0,0]
    ds_write_b128 v3, v[12:15] offset:0
    s_add_u32 s54, s49, 1271808
    buffer_load_dwordx4 v[128:131], v1, s[20:23], s54 offen
    v_fma_mix_f32 v22, v81, v30, v31 op_sel_hi:[1,0,0]
    v_fma_mix_f32 v23, v85, v30, v31 op_sel_hi:[1,0,0]
    v_fma_mix_f32 v24, v89, v30, v31 op_sel_hi:[1,0,0]
    s_add_u32 s54, s49, 1290240
    buffer_load_dwordx4 v[132:135], v1, s[20:23], s54 offen
    v_fma_mix_f32 v25, v93, v30, v31 op_sel_hi:[1,0,0]
    v_fma_mix_f32 v26, v97, v30, v31 op_sel_hi:[1,0,0]
    v_fma_mix_f32 v27, v101, v30, v31 op_sel_hi:[1,0,0]
    s_add_u32 s54, s49, 1308672
    buffer_load_dwordx4 v[136:139], v1, s[20:23], s54 offen
    v_cvt_pk_bf16_f32 v20, v20, v21
    v_cvt_pk_bf16_f32 v21, v22, v23
    v_cvt_pk_bf16_f32 v22, v24, v25
    s_add_u32 s55, s49, 1179648
    buffer_load_dword v140, v2, s[20:23], s55 offen
    v_cvt_pk_bf16_f32 v23, v26, v27
    v_fma_mix_f32 v12, v74, v32, v33 op_sel_hi:[1,0,0]
    v_fma_mix_f32 v13, v78, v32, v33 op_sel_hi:[1,0,0]
    s_add_u32 s55, s49, 1198080
    buffer_load_dword v141, v2, s[20:23], s55 offen
    ds_write_b128 v3, v[20:23] offset:2048
    v_fma_mix_f32 v14, v82, v32, v33 op_sel_hi:[1,0,0]
    v_fma_mix_f32 v15, v86, v32, v33 op_sel_hi:[1,0,0]
    s_add_u32 s55, s49, 1216512
    buffer_load_dword v142, v2, s[20:23], s55 offen
    v_fma_mix_f32 v16, v90, v32, v33 op_sel_hi:[1,0,0]
    v_fma_mix_f32 v17, v94, v32, v33 op_sel_hi:[1,0,0]
    v_fma_mix_f32 v18, v98, v32, v33 op_sel_hi:[1,0,0]
    s_add_u32 s55, s49, 1234944
    buffer_load_dword v143, v2, s[20:23], s55 offen
    v_fma_mix_f32 v19, v102, v32, v33 op_sel_hi:[1,0,0]
    v_cvt_pk_bf16_f32 v12, v12, v13
    v_cvt_pk_bf16_f32 v13, v14, v15
    s_add_u32 m0, s39, 8064
    s_nop 0
    buffer_load_dwordx4 v7, s[16:19], s40 offen offset:128 lds
    v_cvt_pk_bf16_f32 v14, v16, v17
    v_cvt_pk_bf16_f32 v15, v18, v19
    v_fma_mix_f32 v20, v75, v34, v35 op_sel_hi:[1,0,0]
    s_add_u32 m0, s39, 9088
    s_nop 0
    buffer_load_dwordx4 v8, s[16:19], s41 offen offset:128 lds
    v_fma_mix_f32 v21, v79, v34, v35 op_sel_hi:[1,0,0]
    ds_write_b128 v3, v[12:15] offset:4096
    v_fma_mix_f32 v22, v83, v34, v35 op_sel_hi:[1,0,0]
    s_add_u32 m0, s39, 10112
    s_nop 0
    buffer_load_dwordx4 v7, s[16:19], s42 offen offset:128 lds
    v_fma_mix_f32 v23, v87, v34, v35 op_sel_hi:[1,0,0]
    v_fma_mix_f32 v24, v91, v34, v35 op_sel_hi:[1,0,0]
    v_fma_mix_f32 v25, v95, v34, v35 op_sel_hi:[1,0,0]
    s_add_u32 m0, s39, 11136
    s_nop 0
    buffer_load_dwordx4 v8, s[16:19], s43 offen offset:128 lds
    v_fma_mix_f32 v26, v99, v34, v35 op_sel_hi:[1,0,0]
    v_fma_mix_f32 v27, v103, v34, v35 op_sel_hi:[1,0,0]
    v_cvt_pk_bf16_f32 v20, v20, v21
    s_add_u32 m0, s39, 12160
    s_nop 0
    buffer_load_dwordx4 v7, s[16:19], s44 offen offset:128 lds
    v_cvt_pk_bf16_f32 v21, v22, v23
    v_cvt_pk_bf16_f32 v22, v24, v25
    v_cvt_pk_bf16_f32 v23, v26, v27
    s_add_u32 m0, s39, 13184
    s_nop 0
    buffer_load_dwordx4 v8, s[16:19], s45 offen offset:128 lds
    v_fma_mix_f32 v12, v104, v36, v37 op_sel_hi:[1,0,0]
    v_fma_mix_f32 v13, v105, v36, v37 op_sel_hi:[1,0,0]
    ds_write_b128 v3, v[20:23] offset:6144
    s_add_u32 m0, s39, 14208
    s_nop 0
    buffer_load_dwordx4 v7, s[16:19], s46 offen offset:128 lds
    v_fma_mix_f32 v14, v106, v36, v37 op_sel_hi:[1,0,0]
    v_fma_mix_f32 v15, v107, v36, v37 op_sel_hi:[1,0,0]
    v_cvt_pk_bf16_f32 v12, v12, v13
    s_add_u32 m0, s39, 15232
    s_nop 0
    buffer_load_dwordx4 v8, s[16:19], s47 offen offset:128 lds
    v_cvt_pk_bf16_f32 v13, v14, v15
    ds_write_b64 v4, v[12:13] offset:16384
    s_waitcnt vmcnt(20) lgkmcnt(0)
    s_barrier
    v_mov_b32 v68, 0
    ds_read_b128 v[64:67], v68 offset:47232
    s_waitcnt lgkmcnt(0)
    v_or_b32 v64, v64, v65
    v_or3_b32 v64, v64, v66, v67
    s_nop 0
    v_readfirstlane_b32 s58, v64
    s_cmp_lg_u32 s58, 0
    s_cbranch_scc1 L_h_generic
    ds_read_b128 v[28:31], v5 offset:38016
    ds_read_b128 v[32:35], v5 offset:38032
    ds_read_b64 v[36:37], v6 offset:39040
    s_add_u32 s54, s49, 2359296
    buffer_load_dwordx4 v[144:147], v1, s[20:23], s54 offen
    s_waitcnt vmcnt(9) lgkmcnt(0)
    v_fma_mix_f32 v12, v108, v28, v29 op_sel_hi:[1,0,0]
    v_fma_mix_f32 v13, v112, v28, v29 op_sel_hi:[1,0,0]
    v_fma_mix_f32 v14, v116, v28, v29 op_sel_hi:[1,0,0]
    s_add_u32 s54, s49, 2377728
    buffer_load_dwordx4 v[148:151], v1, s[20:23], s54 offen
    v_fma_mix_f32 v15, v120, v28, v29 op_sel_hi:[1,0,0]
    v_fma_mix_f32 v16, v124, v28, v29 op_sel_hi:[1,0,0]
    v_fma_mix_f32 v17, v128, v28, v29 op_sel_hi:[1,0,0]
    s_add_u32 s54, s49, 2396160
    buffer_load_dwordx4 v[152:155], v1, s[20:23], s54 offen
    v_fma_mix_f32 v18, v132, v28, v29 op_sel_hi:[1,0,0]
    v_fma_mix_f32 v19, v136, v28, v29 op_sel_hi:[1,0,0]
    v_cvt_pk_bf16_f32 v12, v12, v13
    s_add_u32 s54, s49, 2414592
    buffer_load_dwordx4 v[156:159], v1, s[20:23], s54 offen
    v_cvt_pk_bf16_f32 v13, v14, v15
    v_cvt_pk_bf16_f32 v14, v16, v17
    v_cvt_pk_bf16_f32 v15, v18, v19
    s_add_u32 s54, s49, 2433024
    buffer_load_dwordx4 v[160:163], v1, s[20:23], s54 offen
    v_fma_mix_f32 v20, v109, v30, v31 op_sel_hi:[1,0,0]
    v_fma_mix_f32 v21, v113, v30, v31 op_sel_hi:[1,0,0]
    ds_write_b128 v3, v[12:15] offset:18432
    s_add_u32 s54, s49, 2451456
    buffer_load_dwordx4 v[164:167], v1, s[20:23], s54 offen
    v_fma_mix_f32 v22, v117, v30, v31 op_sel_hi:[1,0,0]
    v_fma_mix_f32 v23, v121, v30, v31 op_sel_hi:[1,0,0]
    v_fma_mix_f32 v24, v125, v30, v31 op_sel_hi:[1,0,0]
    s_add_u32 s54, s49, 2469888
    buffer_load_dwordx4 v[168:171], v1, s[20:23], s54 offen
    v_fma_mix_f32 v25, v129, v30, v31 op_sel_hi:[1,0,0]
    v_fma_mix_f32 v26, v133, v30, v31 op_sel_hi:[1,0,0]
    v_fma_mix_f32 v27, v137, v30, v31 op_sel_hi:[1,0,0]
    s_add_u32 s54, s49, 2488320
    buffer_load_dwordx4 v[172:175], v1, s[20:23], s54 offen
    v_cvt_pk_bf16_f32 v20, v20, v21
    v_cvt_pk_bf16_f32 v21, v22, v23
    v_cvt_pk_bf16_f32 v22, v24, v25
    s_add_u32 s55, s49, 2359296
    buffer_load_dword v176, v2, s[20:23], s55 offen
    v_cvt_pk_bf16_f32 v23, v26, v27
    v_fma_mix_f32 v12, v110, v32, v33 op_sel_hi:[1,0,0]
    v_fma_mix_f32 v13, v114, v32, v33 op_sel_hi:[1,0,0]
    s_add_u32 s55, s49, 2377728
    buffer_load_dword v177, v2, s[20:23], s55 offen
    ds_write_b128 v3, v[20:23] offset:20480
    v_fma_mix_f32 v14, v118, v32, v33 op_sel_hi:[1,0,0]
    v_fma_mix_f32 v15, v122, v32, v33 op_sel_hi:[1,0,0]
    s_add_u32 s55, s49, 2396160
    buffer_load_dword v178, v2, s[20:23], s55 offen
    v_fma_mix_f32 v16, v126, v32, v33 op_sel_hi:[1,0,0]
    v_fma_mix_f32 v17, v130, v32, v33 op_sel_hi:[1,0,0]
    v_fma_mix_f32 v18, v134, v32, v33 op_sel_hi:[1,0,0]
    s_add_u32 s55, s49, 2414592
    buffer_load_dword v179, v2, s[20:23], s55 offen
    v_fma_mix_f32 v19, v138, v32, v33 op_sel_hi:[1,0,0]
    v_cvt_pk_bf16_f32 v12, v12, v13
    v_cvt_pk_bf16_f32 v13, v14, v15
    s_add_u32 m0, s39, 16128
    s_nop 0
    buffer_load_dwordx4 v7, s[16:19], s40 offen offset:256 lds
    v_cvt_pk_bf16_f32 v14, v16, v17
    v_cvt_pk_bf16_f32 v15, v18, v19
    v_fma_mix_f32 v20, v111, v34, v35 op_sel_hi:[1,0,0]
    s_add_u32 m0, s39, 17152
    s_nop 0
    buffer_load_dwordx4 v8, s[16:19], s41 offen offset:256 lds
    v_fma_mix_f32 v21, v115, v34, v35 op_sel_hi:[1,0,0]
    ds_write_b128 v3, v[12:15] offset:22528
    v_fma_mix_f32 v22, v119, v34, v35 op_sel_hi:[1,0,0]
    s_add_u32 m0, s39, 18176
    s_nop 0
    buffer_load_dwordx4 v7, s[16:19], s42 offen offset:256 lds
    v_fma_mix_f32 v23, v123, v34, v35 op_sel_hi:[1,0,0]
    v_fma_mix_f32 v24, v127, v34, v35 op_sel_hi:[1,0,0]
    v_fma_mix_f32 v25, v131, v34, v35 op_sel_hi:[1,0,0]
    s_add_u32 m0, s39, 19200
    s_nop 0
    buffer_load_dwordx4 v8, s[16:19], s43 offen offset:256 lds
    v_fma_mix_f32 v26, v135, v34, v35 op_sel_hi:[1,0,0]
    v_fma_mix_f32 v27, v139, v34, v35 op_sel_hi:[1,0,0]
    v_cvt_pk_bf16_f32 v20, v20, v21
    s_add_u32 m0, s39, 20224
    s_nop 0
    buffer_load_dwordx4 v7, s[16:19], s44 offen offset:256 lds
    v_cvt_pk_bf16_f32 v21, v22, v23
    v_cvt_pk_bf16_f32 v22, v24, v25
    v_cvt_pk_bf16_f32 v23, v26, v27
    s_add_u32 m0, s39, 21248
    s_nop 0
    buffer_load_dwordx4 v8, s[16:19], s45 offen offset:256 lds
    v_fma_mix_f32 v12, v140, v36, v37 op_sel_hi:[1,0,0]
    v_fma_mix_f32 v13, v141, v36, v37 op_sel_hi:[1,0,0]
    ds_write_b128 v3, v[20:23] offset:24576
    s_add_u32 m0, s39, 22272
    s_nop 0
    buffer_load_dwordx4 v7, s[16:19], s46 offen offset:256 lds
    v_fma_mix_f32 v14, v142, v36, v37 op_sel_hi:[1,0,0]
    v_fma_mix_f32 v15, v143, v36, v37 op_sel_hi:[1,0,0]
    v_cvt_pk_bf16_f32 v12, v12, v13
    s_add_u32 m0, s39, 23296
    s_nop 0
    buffer_load_dwordx4 v8, s[16:19], s47 offen offset:256 lds
    v_cvt_pk_bf16_f32 v13, v14, v15
    ds_write_b64 v4, v[12:13] offset:34816
    ds_read_b128 v[28:31], v5 offset:39168
    ds_read_b128 v[32:35], v5 offset:39184
    ds_read_b64 v[36:37], v6 offset:40192
    s_waitcnt vmcnt(20) lgkmcnt(3)
    s_barrier
    s_add_u32 s54, s49, 3538944
    buffer_load_dwordx4 v[72:75], v1, s[20:23], s54 offen
    s_waitcnt vmcnt(9) lgkmcnt(0)
    v_fma_mix_f32 v12, v144, v28, v29 op_sel_hi:[1,0,0]
    v_fma_mix_f32 v13, v148, v28, v29 op_sel_hi:[1,0,0]
    v_fma_mix_f32 v14, v152, v28, v29 op_sel_hi:[1,0,0]
    s_add_u32 s54, s49, 3557376
    buffer_load_dwordx4 v[76:79], v1, s[20:23], s54 offen
    v_fma_mix_f32 v15, v156, v28, v29 op_sel_hi:[1,0,0]
    v_fma_mix_f32 v16, v160, v28, v29 op_sel_hi:[1,0,0]
    v_fma_mix_f32 v17, v164, v28, v29 op_sel_hi:[1,0,0]
    s_add_u32 s54, s49, 3575808
    buffer_load_dwordx4 v[80:83], v1, s[20:23], s54 offen
    v_fma_mix_f32 v18, v168, v28, v29 op_sel_hi:[1,0,0]
    v_fma_mix_f32 v19, v172, v28, v29 op_sel_hi:[1,0,0]
    v_cvt_pk_bf16_f32 v12, v12, v13
    s_add_u32 s54, s49, 3594240
    buffer_load_dwordx4 v[84:87], v1, s[20:23], s54 offen
    v_cvt_pk_bf16_f32 v13, v14, v15
    v_cvt_pk_bf16_f32 v14, v16, v17
    v_cvt_pk_bf16_f32 v15, v18, v19
    s_add_u32 s54, s49, 3612672
    buffer_load_dwordx4 v[88:91], v1, s[20:23], s54 offen
    v_fma_mix_f32 v20, v145, v30, v31 op_sel_hi:[1,0,0]
    v_fma_mix_f32 v21, v149, v30, v31 op_sel_hi:[1,0,0]
    ds_write_b128 v3, v[12:15] offset:0
    s_add_u32 s54, s49, 3631104
    buffer_load_dwordx4 v[92:95], v1, s[20:23], s54 offen
    v_fma_mix_f32 v22, v153, v30, v31 op_sel_hi:[1,0,0]
    v_fma_mix_f32 v23, v157, v30, v31 op_sel_hi:[1,0,0]
    v_fma_mix_f32 v24, v161, v30, v31 op_sel_hi:[1,0,0]
    s_add_u32 s54, s49, 3649536
    buffer_load_dwordx4 v[96:99], v1, s[20:23], s54 offen
    v_fma_mix_f32 v25, v165, v30, v31 op_sel_hi:[1,0,0]
    v_fma_mix_f32 v26, v169, v30, v31 op_sel_hi:[1,0,0]
    v_fma_mix_f32 v27, v173, v30, v31 op_sel_hi:[1,0,0]
    s_add_u32 s54, s49, 3667968
    buffer_load_dwordx4 v[100:103], v1, s[20:23], s54 offen
    v_cvt_pk_bf16_f32 v20, v20, v21
    v_cvt_pk_bf16_f32 v21, v22, v23
    v_cvt_pk_bf16_f32 v22, v24, v25
    s_add_u32 s55, s49, 3538944
    buffer_load_dword v104, v2, s[20:23], s55 offen
    v_cvt_pk_bf16_f32 v23, v26, v27
    v_fma_mix_f32 v12, v146, v32, v33 op_sel_hi:[1,0,0]
    v_fma_mix_f32 v13, v150, v32, v33 op_sel_hi:[1,0,0]
    s_add_u32 s55, s49, 3557376
    buffer_load_dword v105, v2, s[20:23], s55 offen
    ds_write_b128 v3, v[20:23] offset:2048
    v_fma_mix_f32 v14, v154, v32, v33 op_sel_hi:[1,0,0]
    v_fma_mix_f32 v15, v158, v32, v33 op_sel_hi:[1,0,0]
    s_add_u32 s55, s49, 3575808
    buffer_load_dword v106, v2, s[20:23], s55 offen
    v_fma_mix_f32 v16, v162, v32, v33 op_sel_hi:[1,0,0]
    v_fma_mix_f32 v17, v166, v32, v33 op_sel_hi:[1,0,0]
    v_fma_mix_f32 v18, v170, v32, v33 op_sel_hi:[1,0,0]
    s_add_u32 s55, s49, 3594240
    buffer_load_dword v107, v2, s[20:23], s55 offen
    v_fma_mix_f32 v19, v174, v32, v33 op_sel_hi:[1,0,0]
    v_cvt_pk_bf16_f32 v12, v12, v13
    v_cvt_pk_bf16_f32 v13, v14, v15
    s_sub_u32 m0, s39, 384
    s_nop 0
    buffer_load_dwordx4 v7, s[16:19], s40 offen offset:384 lds
    v_cvt_pk_bf16_f32 v14, v16, v17
    v_cvt_pk_bf16_f32 v15, v18, v19
    v_fma_mix_f32 v20, v147, v34, v35 op_sel_hi:[1,0,0]
    s_add_u32 m0, s39, 640
    s_nop 0
    buffer_load_dwordx4 v8, s[16:19], s41 offen offset:384 lds
    v_fma_mix_f32 v21, v151, v34, v35 op_sel_hi:[1,0,0]
    ds_write_b128 v3, v[12:15] offset:4096
    v_fma_mix_f32 v22, v155, v34, v35 op_sel_hi:[1,0,0]
    s_add_u32 m0, s39, 1664
    s_nop 0
    buffer_load_dwordx4 v7, s[16:19], s42 offen offset:384 lds
    v_fma_mix_f32 v23, v159, v34, v35 op_sel_hi:[1,0,0]
    v_fma_mix_f32 v24, v163, v34, v35 op_sel_hi:[1,0,0]
    v_fma_mix_f32 v25, v167, v34, v35 op_sel_hi:[1,0,0]
    s_add_u32 m0, s39, 2688
    s_nop 0
    buffer_load_dwordx4 v8, s[16:19], s43 offen offset:384 lds
    v_fma_mix_f32 v26, v171, v34, v35 op_sel_hi:[1,0,0]
    v_fma_mix_f32 v27, v175, v34, v35 op_sel_hi:[1,0,0]
    v_cvt_pk_bf16_f32 v20, v20, v21
    s_add_u32 m0, s39, 3712
    s_nop 0
    buffer_load_dwordx4 v7, s[16:19], s44 offen offset:384 lds
    v_cvt_pk_bf16_f32 v21, v22, v23
    v_cvt_pk_bf16_f32 v22, v24, v25
    v_cvt_pk_bf16_f32 v23, v26, v27
    s_add_u32 m0, s39, 4736
    s_nop 0
    buffer_load_dwordx4 v8, s[16:19], s45 offen offset:384 lds
    v_fma_mix_f32 v12, v176, v36, v37 op_sel_hi:[1,0,0]
    v_fma_mix_f32 v13, v177, v36, v37 op_sel_hi:[1,0,0]
    ds_write_b128 v3, v[20:23] offset:6144
    s_add_u32 m0, s39, 5760
    s_nop 0
    buffer_load_dwordx4 v7, s[16:19], s46 offen offset:384 lds
    v_fma_mix_f32 v14, v178, v36, v37 op_sel_hi:[1,0,0]
    v_fma_mix_f32 v15, v179, v36, v37 op_sel_hi:[1,0,0]
    v_cvt_pk_bf16_f32 v12, v12, v13
    s_add_u32 m0, s39, 6784
    s_nop 0
    buffer_load_dwordx4 v8, s[16:19], s47 offen offset:384 lds
    v_cvt_pk_bf16_f32 v13, v14, v15
    ds_write_b64 v4, v[12:13] offset:16384
    ds_read_b128 v[28:31], v5 offset:40320
    ds_read_b128 v[32:35], v5 offset:40336
    ds_read_b64 v[36:37], v6 offset:41344
    s_waitcnt vmcnt(20) lgkmcnt(3)
    s_barrier
    s_add_u32 s54, s49, 4718592
    buffer_load_dwordx4 v[108:111], v1, s[20:23], s54 offen
    s_waitcnt vmcnt(9) lgkmcnt(0)
    v_fma_mix_f32 v12, v72, v28, v29 op_sel_hi:[1,0,0]
    v_fma_mix_f32 v13, v76, v28, v29 op_sel_hi:[1,0,0]
    v_fma_mix_f32 v14, v80, v28, v29 op_sel_hi:[1,0,0]
    s_add_u32 s54, s49, 4737024
    buffer_load_dwordx4 v[112:115], v1, s[20:23], s54 offen
    v_fma_mix_f32 v15, v84, v28, v29 op_sel_hi:[1,0,0]
    v_fma_mix_f32 v16, v88, v28, v29 op_sel_hi:[1,0,0]
    v_fma_mix_f32 v17, v92, v28, v29 op_sel_hi:[1,0,0]
    s_add_u32 s54, s49, 4755456
    buffer_load_dwordx4 v[116:119], v1, s[20:23], s54 offen
    v_fma_mix_f32 v18, v96, v28, v29 op_sel_hi:[1,0,0]
    v_fma_mix_f32 v19, v100, v28, v29 op_sel_hi:[1,0,0]
    v_cvt_pk_bf16_f32 v12, v12, v13
    s_add_u32 s54, s49, 4773888
    buffer_load_dwordx4 v[120:123], v1, s[20:23], s54 offen
    v_cvt_pk_bf16_f32 v13, v14, v15
    v_cvt_pk_bf16_f32 v14, v16, v17
    v_cvt_pk_bf16_f32 v15, v18, v19
    s_add_u32 s54, s49, 4792320
    buffer_load_dwordx4 v[124:127], v1, s[20:23], s54 offen
    v_fma_mix_f32 v20, v73, v30, v31 op_sel_hi:[1,0,0]
    v_fma_mix_f32 v21, v77, v30, v31 op_sel_hi:[1,0,0]
    ds_write_b128 v3, v[12:15] offset:18432
    s_add_u32 s54, s49, 4810752
    buffer_load_dwordx4 v[128:131], v1, s[20:23], s54 offen
    v_fma_mix_f32 v22, v81, v30, v31 op_sel_hi:[1,0,0]
    v_fma_mix_f32 v23, v85, v30, v31 op_sel_hi:[1,0,0]
    v_fma_mix_f32 v24, v89, v30, v31 op_sel_hi:[1,0,0]
    s_add_u32 s54, s49, 4829184
    buffer_load_dwordx4 v[132:135], v1, s[20:23], s54 offen
    v_fma_mix_f32 v25, v93, v30, v31 op_sel_hi:[1,0,0]
    v_fma_mix_f32 v26, v97, v30, v31 op_sel_hi:[1,0,0]
    v_fma_mix_f32 v27, v101, v30, v31 op_sel_hi:[1,0,0]
    s_add_u32 s54, s49, 4847616
    buffer_load_dwordx4 v[136:139], v1, s[20:23], s54 offen
    v_cvt_pk_bf16_f32 v20, v20, v21
    v_cvt_pk_bf16_f32 v21, v22, v23
    v_cvt_pk_bf16_f32 v22, v24, v25
    s_add_u32 s55, s49, 4718592
    buffer_load_dword v140, v2, s[20:23], s55 offen
    v_cvt_pk_bf16_f32 v23, v26, v27
    v_fma_mix_f32 v12, v74, v32, v33 op_sel_hi:[1,0,0]
    v_fma_mix_f32 v13, v78, v32, v33 op_sel_hi:[1,0,0]
    s_add_u32 s55, s49, 4737024
    buffer_load_dword v141, v2, s[20:23], s55 offen
    ds_write_b128 v3, v[20:23] offset:20480
    v_fma_mix_f32 v14, v82, v32, v33 op_sel_hi:[1,0,0]
    v_fma_mix_f32 v15, v86, v32, v33 op_sel_hi:[1,0,0]
    s_add_u32 s55, s49, 4755456
    buffer_load_dword v142, v2, s[20:23], s55 offen
    v_fma_mix_f32 v16, v90, v32, v33 op_sel_hi:[1,0,0]
    v_fma_mix_f32 v17, v94, v32, v33 op_sel_hi:[1,0,0]
    v_fma_mix_f32 v18, v98, v32, v33 op_sel_hi:[1,0,0]
    s_add_u32 s55, s49, 4773888
    buffer_load_dword v143, v2, s[20:23], s55 offen
    v_fma_mix_f32 v19, v102, v32, v33 op_sel_hi:[1,0,0]
    v_cvt_pk_bf16_f32 v12, v12, v13
    v_cvt_pk_bf16_f32 v13, v14, v15
    s_add_u32 m0, s39, 7680
    s_nop 0
    buffer_load_dwordx4 v7, s[16:19], s40 offen offset:512 lds
    v_cvt_pk_bf16_f32 v14, v16, v17
    v_cvt_pk_bf16_f32 v15, v18, v19
    v_fma_mix_f32 v20, v75, v34, v35 op_sel_hi:[1,0,0]
    s_add_u32 m0, s39, 8704
    s_nop 0
    buffer_load_dwordx4 v8, s[16:19], s41 offen offset:512 lds
    v_fma_mix_f32 v21, v79, v34, v35 op_sel_hi:[1,0,0]
    ds_write_b128 v3, v[12:15] offset:22528
    v_fma_mix_f32 v22, v83, v34, v35 op_sel_hi:[1,0,0]
    s_add_u32 m0, s39, 9728
    s_nop 0
    buffer_load_dwordx4 v7, s[16:19], s42 offen offset:512 lds
    v_fma_mix_f32 v23, v87, v34, v35 op_sel_hi:[1,0,0]
    v_fma_mix_f32 v24, v91, v34, v35 op_sel_hi:[1,0,0]
    v_fma_mix_f32 v25, v95, v34, v35 op_sel_hi:[1,0,0]
    s_add_u32 m0, s39, 10752
    s_nop 0
    buffer_load_dwordx4 v8, s[16:19], s43 offen offset:512 lds
    v_fma_mix_f32 v26, v99, v34, v35 op_sel_hi:[1,0,0]
    v_fma_mix_f32 v27, v103, v34, v35 op_sel_hi:[1,0,0]
    v_cvt_pk_bf16_f32 v20, v20, v21
    s_add_u32 m0, s39, 11776
    s_nop 0
    buffer_load_dwordx4 v7, s[16:19], s44 offen offset:512 lds
    v_cvt_pk_bf16_f32 v21, v22, v23
    v_cvt_pk_bf16_f32 v22, v24, v25
    v_cvt_pk_bf16_f32 v23, v26, v27
    s_add_u32 m0, s39, 12800
    s_nop 0
    buffer_load_dwordx4 v8, s[16:19], s45 offen offset:512 lds
    v_fma_mix_f32 v12, v104, v36, v37 op_sel_hi:[1,0,0]
    v_fma_mix_f32 v13, v105, v36, v37 op_sel_hi:[1,0,0]
    ds_write_b128 v3, v[20:23] offset:24576
    s_add_u32 m0, s39, 13824
    s_nop 0
    buffer_load_dwordx4 v7, s[16:19], s46 offen offset:512 lds
    v_fma_mix_f32 v14, v106, v36, v37 op_sel_hi:[1,0,0]
    v_fma_mix_f32 v15, v107, v36, v37 op_sel_hi:[1,0,0]
    v_cvt_pk_bf16_f32 v12, v12, v13
    s_add_u32 m0, s39, 14848
    s_nop 0
    buffer_load_dwordx4 v8, s[16:19], s47 offen offset:512 lds
    v_cvt_pk_bf16_f32 v13, v14, v15
    ds_write_b64 v4, v[12:13] offset:34816
    ds_read_b128 v[28:31], v5 offset:41472
    ds_read_b128 v[32:35], v5 offset:41488
    ds_read_b64 v[36:37], v6 offset:42496
    s_waitcnt vmcnt(20) lgkmcnt(3)
    s_barrier
    s_add_u32 s54, s49, 5898240
    buffer_load_dwordx4 v[144:147], v1, s[20:23], s54 offen
    s_waitcnt vmcnt(9) lgkmcnt(0)
    v_fma_mix_f32 v12, v108, v28, v29 op_sel_hi:[1,0,0]
    v_fma_mix_f32 v13, v112, v28, v29 op_sel_hi:[1,0,0]
    v_fma_mix_f32 v14, v116, v28, v29 op_sel_hi:[1,0,0]
    s_add_u32 s54, s49, 5916672
    buffer_load_dwordx4 v[148:151], v1, s[20:23], s54 offen
    v_fma_mix_f32 v15, v120, v28, v29 op_sel_hi:[1,0,0]
    v_fma_mix_f32 v16, v124, v28, v29 op_sel_hi:[1,0,0]
    v_fma_mix_f32 v17, v128, v28, v29 op_sel_hi:[1,0,0]
    s_add_u32 s54, s49, 5935104
    buffer_load_dwordx4 v[152:155], v1, s[20:23], s54 offen
    v_fma_mix_f32 v18, v132, v28, v29 op_sel_hi:[1,0,0]
    v_fma_mix_f32 v19, v136, v28, v29 op_sel_hi:[1,0,0]
    v_cvt_pk_bf16_f32 v12, v12, v13
    s_add_u32 s54, s49, 5953536
    buffer_load_dwordx4 v[156:159], v1, s[20:23], s54 offen
    v_cvt_pk_bf16_f32 v13, v14, v15
    v_cvt_pk_bf16_f32 v14, v16, v17
    v_cvt_pk_bf16_f32 v15, v18, v19
    s_add_u32 s54, s49, 5971968
    buffer_load_dwordx4 v[160:163], v1, s[20:23], s54 offen
    v_fma_mix_f32 v20, v109, v30, v31 op_sel_hi:[1,0,0]
    v_fma_mix_f32 v21, v113, v30, v31 op_sel_hi:[1,0,0]
    ds_write_b128 v3, v[12:15] offset:0
    s_add_u32 s54, s49, 5990400
    buffer_load_dwordx4 v[164:167], v1, s[20:23], s54 offen
    v_fma_mix_f32 v22, v117, v30, v31 op_sel_hi:[1,0,0]
    v_fma_mix_f32 v23, v121, v30, v31 op_sel_hi:[1,0,0]
    v_fma_mix_f32 v24, v125, v30, v31 op_sel_hi:[1,0,0]
    s_add_u32 s54, s49, 6008832
    buffer_load_dwordx4 v[168:171], v1, s[20:23], s54 offen
    v_fma_mix_f32 v25, v129, v30, v31 op_sel_hi:[1,0,0]
    v_fma_mix_f32 v26, v133, v30, v31 op_sel_hi:[1,0,0]
    v_fma_mix_f32 v27, v137, v30, v31 op_sel_hi:[1,0,0]
    s_add_u32 s54, s49, 6027264
    buffer_load_dwordx4 v[172:175], v1, s[20:23], s54 offen
    v_cvt_pk_bf16_f32 v20, v20, v21
    v_cvt_pk_bf16_f32 v21, v22, v23
    v_cvt_pk_bf16_f32 v22, v24, v25
    s_add_u32 s55, s49, 5898240
    buffer_load_dword v176, v2, s[20:23], s55 offen
    v_cvt_pk_bf16_f32 v23, v26, v27
    v_fma_mix_f32 v12, v110, v32, v33 op_sel_hi:[1,0,0]
    v_fma_mix_f32 v13, v114, v32, v33 op_sel_hi:[1,0,0]
    s_add_u32 s55, s49, 5916672
    buffer_load_dword v177, v2, s[20:23], s55 offen
    ds_write_b128 v3, v[20:23] offset:2048
    v_fma_mix_f32 v14, v118, v32, v33 op_sel_hi:[1,0,0]
    v_fma_mix_f32 v15, v122, v32, v33 op_sel_hi:[1,0,0]
    s_add_u32 s55, s49, 5935104
    buffer_load_dword v178, v2, s[20:23], s55 offen
    v_fma_mix_f32 v16, v126, v32, v33 op_sel_hi:[1,0,0]
    v_fma_mix_f32 v17, v130, v32, v33 op_sel_hi:[1,0,0]
    v_fma_mix_f32 v18, v134, v32, v33 op_sel_hi:[1,0,0]
    s_add_u32 s55, s49, 5953536
    buffer_load_dword v179, v2, s[20:23], s55 offen
    v_fma_mix_f32 v19, v138, v32, v33 op_sel_hi:[1,0,0]
    v_cvt_pk_bf16_f32 v12, v12, v13
    v_cvt_pk_bf16_f32 v13, v14, v15
    s_add_u32 m0, s39, 15744
    s_nop 0
    buffer_load_dwordx4 v7, s[16:19], s40 offen offset:640 lds
    v_cvt_pk_bf16_f32 v14, v16, v17
    v_cvt_pk_bf16_f32 v15, v18, v19
    v_fma_mix_f32 v20, v111, v34, v35 op_sel_hi:[1,0,0]
    s_add_u32 m0, s39, 16768
    s_nop 0
    buffer_load_dwordx4 v8, s[16:19], s41 offen offset:640 lds
    v_fma_mix_f32 v21, v115, v34, v35 op_sel_hi:[1,0,0]
    ds_write_b128 v3, v[12:15] offset:4096
    v_fma_mix_f32 v22, v119, v34, v35 op_sel_hi:[1,0,0]
    s_add_u32 m0, s39, 17792
    s_nop 0
    buffer_load_dwordx4 v7, s[16:19], s42 offen offset:640 lds
    v_fma_mix_f32 v23, v123, v34, v35 op_sel_hi:[1,0,0]
    v_fma_mix_f32 v24, v127, v34, v35 op_sel_hi:[1,0,0]
    v_fma_mix_f32 v25, v131, v34, v35 op_sel_hi:[1,0,0]
    s_add_u32 m0, s39, 18816
    s_nop 0
    buffer_load_dwordx4 v8, s[16:19], s43 offen offset:640 lds
    v_fma_mix_f32 v26, v135, v34, v35 op_sel_hi:[1,0,0]
    v_fma_mix_f32 v27, v139, v34, v35 op_sel_hi:[1,0,0]
    v_cvt_pk_bf16_f32 v20, v20, v21
    s_add_u32 m0, s39, 19840
    s_nop 0
    buffer_load_dwordx4 v7, s[16:19], s44 offen offset:640 lds
    v_cvt_pk_bf16_f32 v21, v22, v23
    v_cvt_pk_bf16_f32 v22, v24, v25
    v_cvt_pk_bf16_f32 v23, v26, v27
    s_add_u32 m0, s39, 20864
    s_nop 0
    buffer_load_dwordx4 v8, s[16:19], s45 offen offset:640 lds
    v_fma_mix_f32 v12, v140, v36, v37 op_sel_hi:[1,0,0]
    v_fma_mix_f32 v13, v141, v36, v37 op_sel_hi:[1,0,0]
    ds_write_b128 v3, v[20:23] offset:6144
    s_add_u32 m0, s39, 21888
    s_nop 0
    buffer_load_dwordx4 v7, s[16:19], s46 offen offset:640 lds
    v_fma_mix_f32 v14, v142, v36, v37 op_sel_hi:[1,0,0]
    v_fma_mix_f32 v15, v143, v36, v37 op_sel_hi:[1,0,0]
    v_cvt_pk_bf16_f32 v12, v12, v13
    s_add_u32 m0, s39, 22912
    s_nop 0
    buffer_load_dwordx4 v8, s[16:19], s47 offen offset:640 lds
    v_cvt_pk_bf16_f32 v13, v14, v15
    ds_write_b64 v4, v[12:13] offset:16384
    ds_read_b128 v[28:31], v5 offset:42624
    ds_read_b128 v[32:35], v5 offset:42640
    ds_read_b64 v[36:37], v6 offset:43648
    s_waitcnt vmcnt(20) lgkmcnt(3)
    s_barrier
    s_add_u32 s54, s49, 7077888
    buffer_load_dwordx4 v[72:75], v1, s[20:23], s54 offen
    s_waitcnt vmcnt(9) lgkmcnt(0)
    v_fma_mix_f32 v12, v144, v28, v29 op_sel_hi:[1,0,0]
    v_fma_mix_f32 v13, v148, v28, v29 op_sel_hi:[1,0,0]
    v_fma_mix_f32 v14, v152, v28, v29 op_sel_hi:[1,0,0]
    s_add_u32 s54, s49, 7096320
    buffer_load_dwordx4 v[76:79], v1, s[20:23], s54 offen
    v_fma_mix_f32 v15, v156, v28, v29 op_sel_hi:[1,0,0]
    v_fma_mix_f32 v16, v160, v28, v29 op_sel_hi:[1,0,0]
    v_fma_mix_f32 v17, v164, v28, v29 op_sel_hi:[1,0,0]
    s_add_u32 s54, s49, 7114752
    buffer_load_dwordx4 v[80:83], v1, s[20:23], s54 offen
    v_fma_mix_f32 v18, v168, v28, v29 op_sel_hi:[1,0,0]
    v_fma_mix_f32 v19, v172, v28, v29 op_sel_hi:[1,0,0]
    v_cvt_pk_bf16_f32 v12, v12, v13
    s_add_u32 s54, s49, 7133184
    buffer_load_dwordx4 v[84:87], v1, s[20:23], s54 offen
    v_cvt_pk_bf16_f32 v13, v14, v15
    v_cvt_pk_bf16_f32 v14, v16, v17
    v_cvt_pk_bf16_f32 v15, v18, v19
    s_add_u32 s54, s49, 7151616
    buffer_load_dwordx4 v[88:91], v1, s[20:23], s54 offen
    v_fma_mix_f32 v20, v145, v30, v31 op_sel_hi:[1,0,0]
    v_fma_mix_f32 v21, v149, v30, v31 op_sel_hi:[1,0,0]
    ds_write_b128 v3, v[12:15] offset:18432
    s_add_u32 s54, s49, 7170048
    buffer_load_dwordx4 v[92:95], v1, s[20:23], s54 offen
    v_fma_mix_f32 v22, v153, v30, v31 op_sel_hi:[1,0,0]
    v_fma_mix_f32 v23, v157, v30, v31 op_sel_hi:[1,0,0]
    v_fma_mix_f32 v24, v161, v30, v31 op_sel_hi:[1,0,0]
    s_add_u32 s54, s49, 7188480
    buffer_load_dwordx4 v[96:99], v1, s[20:23], s54 offen
    v_fma_mix_f32 v25, v165, v30, v31 op_sel_hi:[1,0,0]
    v_fma_mix_f32 v26, v169, v30, v31 op_sel_hi:[1,0,0]
    v_fma_mix_f32 v27, v173, v30, v31 op_sel_hi:[1,0,0]
    s_add_u32 s54, s49, 7206912
    buffer_load_dwordx4 v[100:103], v1, s[20:23], s54 offen
    v_cvt_pk_bf16_f32 v20, v20, v21
    v_cvt_pk_bf16_f32 v21, v22, v23
    v_cvt_pk_bf16_f32 v22, v24, v25
    s_add_u32 s55, s49, 7077888
    buffer_load_dword v104, v2, s[20:23], s55 offen
    v_cvt_pk_bf16_f32 v23, v26, v27
    v_fma_mix_f32 v12, v146, v32, v33 op_sel_hi:[1,0,0]
    v_fma_mix_f32 v13, v150, v32, v33 op_sel_hi:[1,0,0]
    s_add_u32 s55, s49, 7096320
    buffer_load_dword v105, v2, s[20:23], s55 offen
    ds_write_b128 v3, v[20:23] offset:20480
    v_fma_mix_f32 v14, v154, v32, v33 op_sel_hi:[1,0,0]
    v_fma_mix_f32 v15, v158, v32, v33 op_sel_hi:[1,0,0]
    s_add_u32 s55, s49, 7114752
    buffer_load_dword v106, v2, s[20:23], s55 offen
    v_fma_mix_f32 v16, v162, v32, v33 op_sel_hi:[1,0,0]
    v_fma_mix_f32 v17, v166, v32, v33 op_sel_hi:[1,0,0]
    v_fma_mix_f32 v18, v170, v32, v33 op_sel_hi:[1,0,0]
    s_add_u32 s55, s49, 7133184
    buffer_load_dword v107, v2, s[20:23], s55 offen
    v_fma_mix_f32 v19, v174, v32, v33 op_sel_hi:[1,0,0]
    v_cvt_pk_bf16_f32 v12, v12, v13
    v_cvt_pk_bf16_f32 v13, v14, v15
    s_sub_u32 m0, s39, 768
    s_nop 0
    buffer_load_dwordx4 v7, s[16:19], s40 offen offset:768 lds
    v_cvt_pk_bf16_f32 v14, v16, v17
    v_cvt_pk_bf16_f32 v15, v18, v19
    v_fma_mix_f32 v20, v147, v34, v35 op_sel_hi:[1,0,0]
    s_add_u32 m0, s39, 256
    s_nop 0
    buffer_load_dwordx4 v8, s[16:19], s41 offen offset:768 lds
    v_fma_mix_f32 v21, v151, v34, v35 op_sel_hi:[1,0,0]
    ds_write_b128 v3, v[12:15] offset:22528
    v_fma_mix_f32 v22, v155, v34, v35 op_sel_hi:[1,0,0]
    s_add_u32 m0, s39, 1280
    s_nop 0
    buffer_load_dwordx4 v7, s[16:19], s42 offen offset:768 lds
    v_fma_mix_f32 v23, v159, v34, v35 op_sel_hi:[1,0,0]
    v_fma_mix_f32 v24, v163, v34, v35 op_sel_hi:[1,0,0]
    v_fma_mix_f32 v25, v167, v34, v35 op_sel_hi:[1,0,0]
    s_add_u32 m0, s39, 2304
    s_nop 0
    buffer_load_dwordx4 v8, s[16:19], s43 offen offset:768 lds
    v_fma_mix_f32 v26, v171, v34, v35 op_sel_hi:[1,0,0]
    v_fma_mix_f32 v27, v175, v34, v35 op_sel_hi:[1,0,0]
    v_cvt_pk_bf16_f32 v20, v20, v21
    s_add_u32 m0, s39, 3328
    s_nop 0
    buffer_load_dwordx4 v7, s[16:19], s44 offen offset:768 lds
    v_cvt_pk_bf16_f32 v21, v22, v23
    v_cvt_pk_bf16_f32 v22, v24, v25
    v_cvt_pk_bf16_f32 v23, v26, v27
    s_add_u32 m0, s39, 4352
    s_nop 0
    buffer_load_dwordx4 v8, s[16:19], s45 offen offset:768 lds
    v_fma_mix_f32 v12, v176, v36, v37 op_sel_hi:[1,0,0]
    v_fma_mix_f32 v13, v177, v36, v37 op_sel_hi:[1,0,0]
    ds_write_b128 v3, v[20:23] offset:24576
    s_add_u32 m0, s39, 5376
    s_nop 0
    buffer_load_dwordx4 v7, s[16:19], s46 offen offset:768 lds
    v_fma_mix_f32 v14, v178, v36, v37 op_sel_hi:[1,0,0]
    v_fma_mix_f32 v15, v179, v36, v37 op_sel_hi:[1,0,0]
    v_cvt_pk_bf16_f32 v12, v12, v13
    s_add_u32 m0, s39, 6400
    s_nop 0
    buffer_load_dwordx4 v8, s[16:19], s47 offen offset:768 lds
    v_cvt_pk_bf16_f32 v13, v14, v15
    ds_write_b64 v4, v[12:13] offset:34816
    ds_read_b128 v[28:31], v5 offset:43776
    ds_read_b128 v[32:35], v5 offset:43792
    ds_read_b64 v[36:37], v6 offset:44800
    s_waitcnt vmcnt(20) lgkmcnt(3)
    s_barrier
    s_add_u32 s54, s49, 8257536
    buffer_load_dwordx4 v[108:111], v1, s[20:23], s54 offen
    s_waitcnt vmcnt(9) lgkmcnt(0)
    v_fma_mix_f32 v12, v72, v28, v29 op_sel_hi:[1,0,0]
    v_fma_mix_f32 v13, v76, v28, v29 op_sel_hi:[1,0,0]
    v_fma_mix_f32 v14, v80, v28, v29 op_sel_hi:[1,0,0]
    s_add_u32 s54, s49, 8275968
    buffer_load_dwordx4 v[112:115], v1, s[20:23], s54 offen
    v_fma_mix_f32 v15, v84, v28, v29 op_sel_hi:[1,0,0]
    v_fma_mix_f32 v16, v88, v28, v29 op_sel_hi:[1,0,0]
    v_fma_mix_f32 v17, v92, v28, v29 op_sel_hi:[1,0,0]
    s_add_u32 s54, s49, 8294400
    buffer_load_dwordx4 v[116:119], v1, s[20:23], s54 offen
    v_fma_mix_f32 v18, v96, v28, v29 op_sel_hi:[1,0,0]
    v_fma_mix_f32 v19, v100, v28, v29 op_sel_hi:[1,0,0]
    v_cvt_pk_bf16_f32 v12, v12, v13
    s_add_u32 s54, s49, 8312832
    buffer_load_dwordx4 v[120:123], v1, s[20:23], s54 offen
    v_cvt_pk_bf16_f32 v13, v14, v15
    v_cvt_pk_bf16_f32 v14, v16, v17
    v_cvt_pk_bf16_f32 v15, v18, v19
    s_add_u32 s54, s49, 8331264
    buffer_load_dwordx4 v[124:127], v1, s[20:23], s54 offen
    v_fma_mix_f32 v20, v73, v30, v31 op_sel_hi:[1,0,0]
    v_fma_mix_f32 v21, v77, v30, v31 op_sel_hi:[1,0,0]
    ds_write_b128 v3, v[12:15] offset:0
    s_add_u32 s54, s49, 8349696
    buffer_load_dwordx4 v[128:131], v1, s[20:23], s54 offen
    v_fma_mix_f32 v22, v81, v30, v31 op_sel_hi:[1,0,0]
    v_fma_mix_f32 v23, v85, v30, v31 op_sel_hi:[1,0,0]
    v_fma_mix_f32 v24, v89, v30, v31 op_sel_hi:[1,0,0]
    s_add_u32 s54, s49, 8368128
    buffer_load_dwordx4 v[132:135], v1, s[20:23], s54 offen
    v_fma_mix_f32 v25, v93, v30, v31 op_sel_hi:[1,0,0]
    v_fma_mix_f32 v26, v97, v30, v31 op_sel_hi:[1,0,0]
    v_fma_mix_f32 v27, v101, v30, v31 op_sel_hi:[1,0,0]
    s_add_u32 s54, s49, 8386560
    buffer_load_dwordx4 v[136:139], v1, s[20:23], s54 offen
    v_cvt_pk_bf16_f32 v20, v20, v21
    v_cvt_pk_bf16_f32 v21, v22, v23
    v_cvt_pk_bf16_f32 v22, v24, v25
    s_add_u32 s55, s49, 8257536
    buffer_load_dword v140, v2, s[20:23], s55 offen
    v_cvt_pk_bf16_f32 v23, v26, v27
    v_fma_mix_f32 v12, v74, v32, v33 op_sel_hi:[1,0,0]
    v_fma_mix_f32 v13, v78, v32, v33 op_sel_hi:[1,0,0]
    s_add_u32 s55, s49, 8275968
    buffer_load_dword v141, v2, s[20:23], s55 offen
    ds_write_b128 v3, v[20:23] offset:2048
    v_fma_mix_f32 v14, v82, v32, v33 op_sel_hi:[1,0,0]
    v_fma_mix_f32 v15, v86, v32, v33 op_sel_hi:[1,0,0]
    s_add_u32 s55, s49, 8294400
    buffer_load_dword v142, v2, s[20:23], s55 offen
    v_fma_mix_f32 v16, v90, v32, v33 op_sel_hi:[1,0,0]
    v_fma_mix_f32 v17, v94, v32, v33 op_sel_hi:[1,0,0]
    v_fma_mix_f32 v18, v98, v32, v33 op_sel_hi:[1,0,0]
    s_add_u32 s55, s49, 8312832
    buffer_load_dword v143, v2, s[20:23], s55 offen
    v_fma_mix_f32 v19, v102, v32, v33 op_sel_hi:[1,0,0]
    v_cvt_pk_bf16_f32 v12, v12, v13
    v_cvt_pk_bf16_f32 v13, v14, v15
    s_add_u32 m0, s39, 7296
    s_nop 0
    buffer_load_dwordx4 v7, s[16:19], s40 offen offset:896 lds
    v_cvt_pk_bf16_f32 v14, v16, v17
    v_cvt_pk_bf16_f32 v15, v18, v19
    v_fma_mix_f32 v20, v75, v34, v35 op_sel_hi:[1,0,0]
    s_add_u32 m0, s39, 8320
    s_nop 0
    buffer_load_dwordx4 v8, s[16:19], s41 offen offset:896 lds
    v_fma_mix_f32 v21, v79, v34, v35 op_sel_hi:[1,0,0]
    ds_write_b128 v3, v[12:15] offset:4096
    v_fma_mix_f32 v22, v83, v34, v35 op_sel_hi:[1,0,0]
    s_add_u32 m0, s39, 9344
    s_nop 0
    buffer_load_dwordx4 v7, s[16:19], s42 offen offset:896 lds
    v_fma_mix_f32 v23, v87, v34, v35 op_sel_hi:[1,0,0]
    v_fma_mix_f32 v24, v91, v34, v35 op_sel_hi:[1,0,0]
    v_fma_mix_f32 v25, v95, v34, v35 op_sel_hi:[1,0,0]
    s_add_u32 m0, s39, 10368
    s_nop 0
    buffer_load_dwordx4 v8, s[16:19], s43 offen offset:896 lds
    v_fma_mix_f32 v26, v99, v34, v35 op_sel_hi:[1,0,0]
    v_fma_mix_f32 v27, v103, v34, v35 op_sel_hi:[1,0,0]
    v_cvt_pk_bf16_f32 v20, v20, v21
    s_add_u32 m0, s39, 11392
    s_nop 0
    buffer_load_dwordx4 v7, s[16:19], s44 offen offset:896 lds
    v_cvt_pk_bf16_f32 v21, v22, v23
    v_cvt_pk_bf16_f32 v22, v24, v25
    v_cvt_pk_bf16_f32 v23, v26, v27
    s_add_u32 m0, s39, 12416
    s_nop 0
    buffer_load_dwordx4 v8, s[16:19], s45 offen offset:896 lds
    v_fma_mix_f32 v12, v104, v36, v37 op_sel_hi:[1,0,0]
    v_fma_mix_f32 v13, v105, v36, v37 op_sel_hi:[1,0,0]
    ds_write_b128 v3, v[20:23] offset:6144
    s_add_u32 m0, s39, 13440
    s_nop 0
    buffer_load_dwordx4 v7, s[16:19], s46 offen offset:896 lds
    v_fma_mix_f32 v14, v106, v36, v37 op_sel_hi:[1,0,0]
    v_fma_mix_f32 v15, v107, v36, v37 op_sel_hi:[1,0,0]
    v_cvt_pk_bf16_f32 v12, v12, v13
    s_add_u32 m0, s39, 14464
    s_nop 0
    buffer_load_dwordx4 v8, s[16:19], s47 offen offset:896 lds
    v_cvt_pk_bf16_f32 v13, v14, v15
    ds_write_b64 v4, v[12:13] offset:16384
    ds_read_b128 v[28:31], v5 offset:44928
    ds_read_b128 v[32:35], v5 offset:44944
    ds_read_b64 v[36:37], v6 offset:45952
    s_waitcnt vmcnt(20) lgkmcnt(3)
    s_barrier
    s_add_u32 s54, s49, 9437184
    buffer_load_dwordx4 v[144:147], v1, s[20:23], s54 offen
    s_waitcnt vmcnt(9) lgkmcnt(0)
    v_fma_mix_f32 v12, v108, v28, v29 op_sel_hi:[1,0,0]
    v_fma_mix_f32 v13, v112, v28, v29 op_sel_hi:[1,0,0]
    v_fma_mix_f32 v14, v116, v28, v29 op_sel_hi:[1,0,0]
    s_add_u32 s54, s49, 9455616
    buffer_load_dwordx4 v[148:151], v1, s[20:23], s54 offen
    v_fma_mix_f32 v15, v120, v28, v29 op_sel_hi:[1,0,0]
    v_fma_mix_f32 v16, v124, v28, v29 op_sel_hi:[1,0,0]
    v_fma_mix_f32 v17, v128, v28, v29 op_sel_hi:[1,0,0]
    s_add_u32 s54, s49, 9474048
    buffer_load_dwordx4 v[152:155], v1, s[20:23], s54 offen
    v_fma_mix_f32 v18, v132, v28, v29 op_sel_hi:[1,0,0]
    v_fma_mix_f32 v19, v136, v28, v29 op_sel_hi:[1,0,0]
    v_cvt_pk_bf16_f32 v12, v12, v13
    s_add_u32 s54, s49, 9492480
    buffer_load_dwordx4 v[156:159], v1, s[20:23], s54 offen
    v_cvt_pk_bf16_f32 v13, v14, v15
    v_cvt_pk_bf16_f32 v14, v16, v17
    v_cvt_pk_bf16_f32 v15, v18, v19
    s_add_u32 s54, s49, 9510912
    buffer_load_dwordx4 v[160:163], v1, s[20:23], s54 offen
    v_fma_mix_f32 v20, v109, v30, v31 op_sel_hi:[1,0,0]
    v_fma_mix_f32 v21, v113, v30, v31 op_sel_hi:[1,0,0]
    ds_write_b128 v3, v[12:15] offset:18432
    s_add_u32 s54, s49, 9529344
    buffer_load_dwordx4 v[164:167], v1, s[20:23], s54 offen
    v_fma_mix_f32 v22, v117, v30, v31 op_sel_hi:[1,0,0]
    v_fma_mix_f32 v23, v121, v30, v31 op_sel_hi:[1,0,0]
    v_fma_mix_f32 v24, v125, v30, v31 op_sel_hi:[1,0,0]
    s_add_u32 s54, s49, 9547776
    buffer_load_dwordx4 v[168:171], v1, s[20:23], s54 offen
    v_fma_mix_f32 v25, v129, v30, v31 op_sel_hi:[1,0,0]
    v_fma_mix_f32 v26, v133, v30, v31 op_sel_hi:[1,0,0]
    v_fma_mix_f32 v27, v137, v30, v31 op_sel_hi:[1,0,0]
    s_add_u32 s54, s49, 9566208
    buffer_load_dwordx4 v[172:175], v1, s[20:23], s54 offen
    v_cvt_pk_bf16_f32 v20, v20, v21
    v_cvt_pk_bf16_f32 v21, v22, v23
    v_cvt_pk_bf16_f32 v22, v24, v25
    s_add_u32 s55, s49, 9437184
    buffer_load_dword v176, v2, s[20:23], s55 offen
    v_cvt_pk_bf16_f32 v23, v26, v27
    v_fma_mix_f32 v12, v110, v32, v33 op_sel_hi:[1,0,0]
    v_fma_mix_f32 v13, v114, v32, v33 op_sel_hi:[1,0,0]
    s_add_u32 s55, s49, 9455616
    buffer_load_dword v177, v2, s[20:23], s55 offen
    ds_write_b128 v3, v[20:23] offset:20480
    v_fma_mix_f32 v14, v118, v32, v33 op_sel_hi:[1,0,0]
    v_fma_mix_f32 v15, v122, v32, v33 op_sel_hi:[1,0,0]
    s_add_u32 s55, s49, 9474048
    buffer_load_dword v178, v2, s[20:23], s55 offen
    v_fma_mix_f32 v16, v126, v32, v33 op_sel_hi:[1,0,0]
    v_fma_mix_f32 v17, v130, v32, v33 op_sel_hi:[1,0,0]
    v_fma_mix_f32 v18, v134, v32, v33 op_sel_hi:[1,0,0]
    s_add_u32 s55, s49, 9492480
    buffer_load_dword v179, v2, s[20:23], s55 offen
    v_fma_mix_f32 v19, v138, v32, v33 op_sel_hi:[1,0,0]
    v_cvt_pk_bf16_f32 v12, v12, v13
    v_cvt_pk_bf16_f32 v13, v14, v15
    s_add_u32 m0, s39, 15360
    s_nop 0
    buffer_load_dwordx4 v7, s[16:19], s40 offen offset:1024 lds
    v_cvt_pk_bf16_f32 v14, v16, v17
    v_cvt_pk_bf16_f32 v15, v18, v19
    v_fma_mix_f32 v20, v111, v34, v35 op_sel_hi:[1,0,0]
    s_add_u32 m0, s39, 16384
    s_nop 0
    buffer_load_dwordx4 v8, s[16:19], s41 offen offset:1024 lds
    v_fma_mix_f32 v21, v115, v34, v35 op_sel_hi:[1,0,0]
    ds_write_b128 v3, v[12:15] offset:22528
    v_fma_mix_f32 v22, v119, v34, v35 op_sel_hi:[1,0,0]
    s_add_u32 m0, s39, 17408
    s_nop 0
    buffer_load_dwordx4 v7, s[16:19], s42 offen offset:1024 lds
    v_fma_mix_f32 v23, v123, v34, v35 op_sel_hi:[1,0,0]
    v_fma_mix_f32 v24, v127, v34, v35 op_sel_hi:[1,0,0]
    v_fma_mix_f32 v25, v131, v34, v35 op_sel_hi:[1,0,0]
    s_add_u32 m0, s39, 18432
    s_nop 0
    buffer_load_dwordx4 v8, s[16:19], s43 offen offset:1024 lds
    v_fma_mix_f32 v26, v135, v34, v35 op_sel_hi:[1,0,0]
    v_fma_mix_f32 v27, v139, v34, v35 op_sel_hi:[1,0,0]
    v_cvt_pk_bf16_f32 v20, v20, v21
    s_add_u32 m0, s39, 19456
    s_nop 0
    buffer_load_dwordx4 v7, s[16:19], s44 offen offset:1024 lds
    v_cvt_pk_bf16_f32 v21, v22, v23
    v_cvt_pk_bf16_f32 v22, v24, v25
    v_cvt_pk_bf16_f32 v23, v26, v27
    s_add_u32 m0, s39, 20480
    s_nop 0
    buffer_load_dwordx4 v8, s[16:19], s45 offen offset:1024 lds
    v_fma_mix_f32 v12, v140, v36, v37 op_sel_hi:[1,0,0]
    v_fma_mix_f32 v13, v141, v36, v37 op_sel_hi:[1,0,0]
    ds_write_b128 v3, v[20:23] offset:24576
    s_add_u32 m0, s39, 21504
    s_nop 0
    buffer_load_dwordx4 v7, s[16:19], s46 offen offset:1024 lds
    v_fma_mix_f32 v14, v142, v36, v37 op_sel_hi:[1,0,0]
    v_fma_mix_f32 v15, v143, v36, v37 op_sel_hi:[1,0,0]
    v_cvt_pk_bf16_f32 v12, v12, v13
    s_add_u32 m0, s39, 22528
    s_nop 0
    buffer_load_dwordx4 v8, s[16:19], s47 offen offset:1024 lds
    v_cvt_pk_bf16_f32 v13, v14, v15
    ds_write_b64 v4, v[12:13] offset:34816
    ds_read_b128 v[28:31], v5 offset:46080
    ds_read_b128 v[32:35], v5 offset:46096
    ds_read_b64 v[36:37], v6 offset:47104
    s_waitcnt vmcnt(20) lgkmcnt(3)
    s_barrier
    s_waitcnt vmcnt(8) lgkmcnt(0)
    v_fma_mix_f32 v12, v144, v28, v29 op_sel_hi:[1,0,0]
    v_fma_mix_f32 v13, v148, v28, v29 op_sel_hi:[1,0,0]
    v_fma_mix_f32 v14, v152, v28, v29 op_sel_hi:[1,0,0]
    v_fma_mix_f32 v15, v156, v28, v29 op_sel_hi:[1,0,0]
    v_fma_mix_f32 v16, v160, v28, v29 op_sel_hi:[1,0,0]
    v_fma_mix_f32 v17, v164, v28, v29 op_sel_hi:[1,0,0]
    v_fma_mix_f32 v18, v168, v28, v29 op_sel_hi:[1,0,0]
    v_fma_mix_f32 v19, v172, v28, v29 op_sel_hi:[1,0,0]
    v_cvt_pk_bf16_f32 v12, v12, v13
    v_cvt_pk_bf16_f32 v13, v14, v15
    v_cvt_pk_bf16_f32 v14, v16, v17
    v_cvt_pk_bf16_f32 v15, v18, v19
    v_fma_mix_f32 v20, v145, v30, v31 op_sel_hi:[1,0,0]
    v_fma_mix_f32 v21, v149, v30, v31 op_sel_hi:[1,0,0]
    ds_write_b128 v3, v[12:15] offset:0
    v_fma_mix_f32 v22, v153, v30, v31 op_sel_hi:[1,0,0]
    v_fma_mix_f32 v23, v157, v30, v31 op_sel_hi:[1,0,0]
    v_fma_mix_f32 v24, v161, v30, v31 op_sel_hi:[1,0,0]
    v_fma_mix_f32 v25, v165, v30, v31 op_sel_hi:[1,0,0]
    v_fma_mix_f32 v26, v169, v30, v31 op_sel_hi:[1,0,0]
    v_fma_mix_f32 v27, v173, v30, v31 op_sel_hi:[1,0,0]
    v_cvt_pk_bf16_f32 v20, v20, v21
    v_cvt_pk_bf16_f32 v21, v22, v23
    v_cvt_pk_bf16_f32 v22, v24, v25
    v_cvt_pk_bf16_f32 v23, v26, v27
    v_fma_mix_f32 v12, v146, v32, v33 op_sel_hi:[1,0,0]
    v_fma_mix_f32 v13, v150, v32, v33 op_sel_hi:[1,0,0]
    ds_write_b128 v3, v[20:23] offset:2048
    v_fma_mix_f32 v14, v154, v32, v33 op_sel_hi:[1,0,0]
    v_fma_mix_f32 v15, v158, v32, v33 op_sel_hi:[1,0,0]
    v_fma_mix_f32 v16, v162, v32, v33 op_sel_hi:[1,0,0]
    v_fma_mix_f32 v17, v166, v32, v33 op_sel_hi:[1,0,0]
    v_fma_mix_f32 v18, v170, v32, v33 op_sel_hi:[1,0,0]
    v_fma_mix_f32 v19, v174, v32, v33 op_sel_hi:[1,0,0]
    v_cvt_pk_bf16_f32 v12, v12, v13
    v_cvt_pk_bf16_f32 v13, v14, v15
    v_cvt_pk_bf16_f32 v14, v16, v17
    v_cvt_pk_bf16_f32 v15, v18, v19
    v_fma_mix_f32 v20, v147, v34, v35 op_sel_hi:[1,0,0]
    v_fma_mix_f32 v21, v151, v34, v35 op_sel_hi:[1,0,0]
    ds_write_b128 v3, v[12:15] offset:4096
    v_fma_mix_f32 v22, v155, v34, v35 op_sel_hi:[1,0,0]
    v_fma_mix_f32 v23, v159, v34, v35 op_sel_hi:[1,0,0]
    v_fma_mix_f32 v24, v163, v34, v35 op_sel_hi:[1,0,0]
    v_fma_mix_f32 v25, v167, v34, v35 op_sel_hi:[1,0,0]
    v_fma_mix_f32 v26, v171, v34, v35 op_sel_hi:[1,0,0]
    v_fma_mix_f32 v27, v175, v34, v35 op_sel_hi:[1,0,0]
    v_cvt_pk_bf16_f32 v20, v20, v21
    v_cvt_pk_bf16_f32 v21, v22, v23
    v_cvt_pk_bf16_f32 v22, v24, v25
    v_cvt_pk_bf16_f32 v23, v26, v27
    v_fma_mix_f32 v12, v176, v36, v37 op_sel_hi:[1,0,0]
    v_fma_mix_f32 v13, v177, v36, v37 op_sel_hi:[1,0,0]
    ds_write_b128 v3, v[20:23] offset:6144
    v_fma_mix_f32 v14, v178, v36, v37 op_sel_hi:[1,0,0]
    v_fma_mix_f32 v15, v179, v36, v37 op_sel_hi:[1,0,0]
    v_cvt_pk_bf16_f32 v12, v12, v13
    v_cvt_pk_bf16_f32 v13, v14, v15
    ds_write_b64 v4, v[12:13] offset:16384
    s_waitcnt vmcnt(0) lgkmcnt(0)
    s_barrier
    s_endpgm
L_h_generic:
    s_barrier
    s_barrier
    ds_read_b128 v[28:31], v5 offset:36864
    ds_read_b128 v[32:35], v5 offset:36880
    ds_read_b64 v[36:37], v6 offset:37888
    s_waitcnt lgkmcnt(0)
    v_cvt_f32_i32 v12, v72
    v_cvt_pk_bf16_f32 v12, 0, v12
    v_add_f32 v12, v12, v29
    v_cvt_pk_bf16_f32 v12, 0, v12
    v_mul_f32 v12, v12, v28
    v_cvt_f32_i32 v13, v76
    v_cvt_pk_bf16_f32 v13, 0, v13
    v_add_f32 v13, v13, v29
    v_cvt_pk_bf16_f32 v13, 0, v13
    v_mul_f32 v13, v13, v28
    v_cvt_f32_i32 v14, v80
    v_cvt_pk_bf16_f32 v14, 0, v14
    v_add_f32 v14, v14, v29
    v_cvt_pk_bf16_f32 v14, 0, v14
    v_mul_f32 v14, v14, v28
    v_cvt_f32_i32 v15, v84
    v_cvt_pk_bf16_f32 v15, 0, v15
    v_add_f32 v15, v15, v29
    v_cvt_pk_bf16_f32 v15, 0, v15
    v_mul_f32 v15, v15, v28
    v_cvt_f32_i32 v16, v88
    v_cvt_pk_bf16_f32 v16, 0, v16
    v_add_f32 v16, v16, v29
    v_cvt_pk_bf16_f32 v16, 0, v16
    v_mul_f32 v16, v16, v28
    v_cvt_f32_i32 v17, v92
    v_cvt_pk_bf16_f32 v17, 0, v17
    v_add_f32 v17, v17, v29
    v_cvt_pk_bf16_f32 v17, 0, v17
    v_mul_f32 v17, v17, v28
    v_cvt_f32_i32 v18, v96
    v_cvt_pk_bf16_f32 v18, 0, v18
    v_add_f32 v18, v18, v29
    v_cvt_pk_bf16_f32 v18, 0, v18
    v_mul_f32 v18, v18, v28
    v_cvt_f32_i32 v19, v100
    v_cvt_pk_bf16_f32 v19, 0, v19
    v_add_f32 v19, v19, v29
    v_cvt_pk_bf16_f32 v19, 0, v19
    v_mul_f32 v19, v19, v28
    v_cvt_pk_bf16_f32 v12, v12, v13
    v_cvt_pk_bf16_f32 v13, v14, v15
    v_cvt_pk_bf16_f32 v14, v16, v17
    v_cvt_pk_bf16_f32 v15, v18, v19
    v_cvt_f32_i32 v20, v73
    v_cvt_pk_bf16_f32 v20, 0, v20
    v_add_f32 v20, v20, v31
    v_cvt_pk_bf16_f32 v20, 0, v20
    v_mul_f32 v20, v20, v30
    v_cvt_f32_i32 v21, v77
    v_cvt_pk_bf16_f32 v21, 0, v21
    v_add_f32 v21, v21, v31
    v_cvt_pk_bf16_f32 v21, 0, v21
    v_mul_f32 v21, v21, v30
    ds_write_b128 v3, v[12:15] offset:0
    v_cvt_f32_i32 v22, v81
    v_cvt_pk_bf16_f32 v22, 0, v22
    v_add_f32 v22, v22, v31
    v_cvt_pk_bf16_f32 v22, 0, v22
    v_mul_f32 v22, v22, v30
    v_cvt_f32_i32 v23, v85
    v_cvt_pk_bf16_f32 v23, 0, v23
    v_add_f32 v23, v23, v31
    v_cvt_pk_bf16_f32 v23, 0, v23
    v_mul_f32 v23, v23, v30
    v_cvt_f32_i32 v24, v89
    v_cvt_pk_bf16_f32 v24, 0, v24
    v_add_f32 v24, v24, v31
    v_cvt_pk_bf16_f32 v24, 0, v24
    v_mul_f32 v24, v24, v30
    v_cvt_f32_i32 v25, v93
    v_cvt_pk_bf16_f32 v25, 0, v25
    v_add_f32 v25, v25, v31
    v_cvt_pk_bf16_f32 v25, 0, v25
    v_mul_f32 v25, v25, v30
    v_cvt_f32_i32 v26, v97
    v_cvt_pk_bf16_f32 v26, 0, v26
    v_add_f32 v26, v26, v31
    v_cvt_pk_bf16_f32 v26, 0, v26
    v_mul_f32 v26, v26, v30
    v_cvt_f32_i32 v27, v101
    v_cvt_pk_bf16_f32 v27, 0, v27
    v_add_f32 v27, v27, v31
    v_cvt_pk_bf16_f32 v27, 0, v27
    v_mul_f32 v27, v27, v30
    v_cvt_pk_bf16_f32 v20, v20, v21
    v_cvt_pk_bf16_f32 v21, v22, v23
    v_cvt_pk_bf16_f32 v22, v24, v25
    v_cvt_pk_bf16_f32 v23, v26, v27
    v_cvt_f32_i32 v12, v74
    v_cvt_pk_bf16_f32 v12, 0, v12
    v_add_f32 v12, v12, v33
    v_cvt_pk_bf16_f32 v12, 0, v12
    v_mul_f32 v12, v12, v32
    v_cvt_f32_i32 v13, v78
    v_cvt_pk_bf16_f32 v13, 0, v13
    v_add_f32 v13, v13, v33
    v_cvt_pk_bf16_f32 v13, 0, v13
    v_mul_f32 v13, v13, v32
    ds_write_b128 v3, v[20:23] offset:2048
    v_cvt_f32_i32 v14, v82
    v_cvt_pk_bf16_f32 v14, 0, v14
    v_add_f32 v14, v14, v33
    v_cvt_pk_bf16_f32 v14, 0, v14
    v_mul_f32 v14, v14, v32
    v_cvt_f32_i32 v15, v86
    v_cvt_pk_bf16_f32 v15, 0, v15
    v_add_f32 v15, v15, v33
    v_cvt_pk_bf16_f32 v15, 0, v15
    v_mul_f32 v15, v15, v32
    v_cvt_f32_i32 v16, v90
    v_cvt_pk_bf16_f32 v16, 0, v16
    v_add_f32 v16, v16, v33
    v_cvt_pk_bf16_f32 v16, 0, v16
    v_mul_f32 v16, v16, v32
    v_cvt_f32_i32 v17, v94
    v_cvt_pk_bf16_f32 v17, 0, v17
    v_add_f32 v17, v17, v33
    v_cvt_pk_bf16_f32 v17, 0, v17
    v_mul_f32 v17, v17, v32
    v_cvt_f32_i32 v18, v98
    v_cvt_pk_bf16_f32 v18, 0, v18
    v_add_f32 v18, v18, v33
    v_cvt_pk_bf16_f32 v18, 0, v18
    v_mul_f32 v18, v18, v32
    v_cvt_f32_i32 v19, v102
    v_cvt_pk_bf16_f32 v19, 0, v19
    v_add_f32 v19, v19, v33
    v_cvt_pk_bf16_f32 v19, 0, v19
    v_mul_f32 v19, v19, v32
    v_cvt_pk_bf16_f32 v12, v12, v13
    v_cvt_pk_bf16_f32 v13, v14, v15
    v_cvt_pk_bf16_f32 v14, v16, v17
    v_cvt_pk_bf16_f32 v15, v18, v19
    v_cvt_f32_i32 v20, v75
    v_cvt_pk_bf16_f32 v20, 0, v20
    v_add_f32 v20, v20, v35
    v_cvt_pk_bf16_f32 v20, 0, v20
    v_mul_f32 v20, v20, v34
    v_cvt_f32_i32 v21, v79
    v_cvt_pk_bf16_f32 v21, 0, v21
    v_add_f32 v21, v21, v35
    v_cvt_pk_bf16_f32 v21, 0, v21
    v_mul_f32 v21, v21, v34
    ds_write_b128 v3, v[12:15] offset:4096
    v_cvt_f32_i32 v22, v83
    v_cvt_pk_bf16_f32 v22, 0, v22
    v_add_f32 v22, v22, v35
    v_cvt_pk_bf16_f32 v22, 0, v22
    v_mul_f32 v22, v22, v34
    v_cvt_f32_i32 v23, v87
    v_cvt_pk_bf16_f32 v23, 0, v23
    v_add_f32 v23, v23, v35
    v_cvt_pk_bf16_f32 v23, 0, v23
    v_mul_f32 v23, v23, v34
    v_cvt_f32_i32 v24, v91
    v_cvt_pk_bf16_f32 v24, 0, v24
    v_add_f32 v24, v24, v35
    v_cvt_pk_bf16_f32 v24, 0, v24
    v_mul_f32 v24, v24, v34
    v_cvt_f32_i32 v25, v95
    v_cvt_pk_bf16_f32 v25, 0, v25
    v_add_f32 v25, v25, v35
    v_cvt_pk_bf16_f32 v25, 0, v25
    v_mul_f32 v25, v25, v34
    v_cvt_f32_i32 v26, v99
    v_cvt_pk_bf16_f32 v26, 0, v26
    v_add_f32 v26, v26, v35
    v_cvt_pk_bf16_f32 v26, 0, v26
    v_mul_f32 v26, v26, v34
    v_cvt_f32_i32 v27, v103
    v_cvt_pk_bf16_f32 v27, 0, v27
    v_add_f32 v27, v27, v35
    v_cvt_pk_bf16_f32 v27, 0, v27
    v_mul_f32 v27, v27, v34
    v_cvt_pk_bf16_f32 v20, v20, v21
    v_cvt_pk_bf16_f32 v21, v22, v23
    v_cvt_pk_bf16_f32 v22, v24, v25
    v_cvt_pk_bf16_f32 v23, v26, v27
    v_cvt_f32_i32 v12, v104
    v_cvt_pk_bf16_f32 v12, 0, v12
    v_add_f32 v12, v12, v37
    v_cvt_pk_bf16_f32 v12, 0, v12
    v_mul_f32 v12, v12, v36
    v_cvt_f32_i32 v13, v105
    v_cvt_pk_bf16_f32 v13, 0, v13
    v_add_f32 v13, v13, v37
    v_cvt_pk_bf16_f32 v13, 0, v13
    v_mul_f32 v13, v13, v36
    ds_write_b128 v3, v[20:23] offset:6144
    v_cvt_f32_i32 v14, v106
    v_cvt_pk_bf16_f32 v14, 0, v14
    v_add_f32 v14, v14, v37
    v_cvt_pk_bf16_f32 v14, 0, v14
    v_mul_f32 v14, v14, v36
    v_cvt_f32_i32 v15, v107
    v_cvt_pk_bf16_f32 v15, 0, v15
    v_add_f32 v15, v15, v37
    v_cvt_pk_bf16_f32 v15, 0, v15
    v_mul_f32 v15, v15, v36
    v_cvt_pk_bf16_f32 v12, v12, v13
    v_cvt_pk_bf16_f32 v13, v14, v15
    ds_write_b64 v4, v[12:13] offset:16384
    s_waitcnt lgkmcnt(0)
    s_barrier
    ds_read_b128 v[28:31], v5 offset:38016
    ds_read_b128 v[32:35], v5 offset:38032
    ds_read_b64 v[36:37], v6 offset:39040
    s_add_u32 s54, s49, 2359296
    buffer_load_dwordx4 v[144:147], v1, s[20:23], s54 offen
    s_waitcnt vmcnt(9) lgkmcnt(0)
    v_cvt_f32_i32 v12, v108
    v_cvt_pk_bf16_f32 v12, 0, v12
    v_add_f32 v12, v12, v29
    v_cvt_pk_bf16_f32 v12, 0, v12
    v_mul_f32 v12, v12, v28
    v_cvt_f32_i32 v13, v112
    v_cvt_pk_bf16_f32 v13, 0, v13
    v_add_f32 v13, v13, v29
    v_cvt_pk_bf16_f32 v13, 0, v13
    v_mul_f32 v13, v13, v28
    v_cvt_f32_i32 v14, v116
    v_cvt_pk_bf16_f32 v14, 0, v14
    v_add_f32 v14, v14, v29
    v_cvt_pk_bf16_f32 v14, 0, v14
    v_mul_f32 v14, v14, v28
    s_add_u32 s54, s49, 2377728
    buffer_load_dwordx4 v[148:151], v1, s[20:23], s54 offen
    v_cvt_f32_i32 v15, v120
    v_cvt_pk_bf16_f32 v15, 0, v15
    v_add_f32 v15, v15, v29
    v_cvt_pk_bf16_f32 v15, 0, v15
    v_mul_f32 v15, v15, v28
    v_cvt_f32_i32 v16, v124
    v_cvt_pk_bf16_f32 v16, 0, v16
    v_add_f32 v16, v16, v29
    v_cvt_pk_bf16_f32 v16, 0, v16
    v_mul_f32 v16, v16, v28
    v_cvt_f32_i32 v17, v128
    v_cvt_pk_bf16_f32 v17, 0, v17
    v_add_f32 v17, v17, v29
    v_cvt_pk_bf16_f32 v17, 0, v17
    v_mul_f32 v17, v17, v28
    s_add_u32 s54, s49, 2396160
    buffer_load_dwordx4 v[152:155], v1, s[20:23], s54 offen
    v_cvt_f32_i32 v18, v132
    v_cvt_pk_bf16_f32 v18, 0, v18
    v_add_f32 v18, v18, v29
    v_cvt_pk_bf16_f32 v18, 0, v18
    v_mul_f32 v18, v18, v28
    v_cvt_f32_i32 v19, v136
    v_cvt_pk_bf16_f32 v19, 0, v19
    v_add_f32 v19, v19, v29
    v_cvt_pk_bf16_f32 v19, 0, v19
    v_mul_f32 v19, v19, v28
    v_cvt_pk_bf16_f32 v12, v12, v13
    v_cvt_pk_bf16_f32 v13, v14, v15
    v_cvt_pk_bf16_f32 v14, v16, v17
    v_cvt_pk_bf16_f32 v15, v18, v19
    v_cvt_f32_i32 v20, v109
    s_add_u32 s54, s49, 2414592
    buffer_load_dwordx4 v[156:159], v1, s[20:23], s54 offen
    v_cvt_pk_bf16_f32 v20, 0, v20
    v_add_f32 v20, v20, v31
    v_cvt_pk_bf16_f32 v20, 0, v20
    v_mul_f32 v20, v20, v30
    v_cvt_f32_i32 v21, v113
    v_cvt_pk_bf16_f32 v21, 0, v21
    v_add_f32 v21, v21, v31
    v_cvt_pk_bf16_f32 v21, 0, v21
    v_mul_f32 v21, v21, v30
    ds_write_b128 v3, v[12:15] offset:18432
    v_cvt_f32_i32 v22, v117
    v_cvt_pk_bf16_f32 v22, 0, v22
    v_add_f32 v22, v22, v31
    v_cvt_pk_bf16_f32 v22, 0, v22
    v_mul_f32 v22, v22, v30
    s_add_u32 s54, s49, 2433024
    buffer_load_dwordx4 v[160:163], v1, s[20:23], s54 offen
    v_cvt_f32_i32 v23, v121
    v_cvt_pk_bf16_f32 v23, 0, v23
    v_add_f32 v23, v23, v31
    v_cvt_pk_bf16_f32 v23, 0, v23
    v_mul_f32 v23, v23, v30
    v_cvt_f32_i32 v24, v125
    v_cvt_pk_bf16_f32 v24, 0, v24
    v_add_f32 v24, v24, v31
    v_cvt_pk_bf16_f32 v24, 0, v24
    v_mul_f32 v24, v24, v30
    v_cvt_f32_i32 v25, v129
    v_cvt_pk_bf16_f32 v25, 0, v25
    v_add_f32 v25, v25, v31
    v_cvt_pk_bf16_f32 v25, 0, v25
    v_mul_f32 v25, v25, v30
    s_add_u32 s54, s49, 2451456
    buffer_load_dwordx4 v[164:167], v1, s[20:23], s54 offen
    v_cvt_f32_i32 v26, v133
    v_cvt_pk_bf16_f32 v26, 0, v26
    v_add_f32 v26, v26, v31
    v_cvt_pk_bf16_f32 v26, 0, v26
    v_mul_f32 v26, v26, v30
    v_cvt_f32_i32 v27, v137
    v_cvt_pk_bf16_f32 v27, 0, v27
    v_add_f32 v27, v27, v31
    v_cvt_pk_bf16_f32 v27, 0, v27
    v_mul_f32 v27, v27, v30
    v_cvt_pk_bf16_f32 v20, v20, v21
    v_cvt_pk_bf16_f32 v21, v22, v23
    v_cvt_pk_bf16_f32 v22, v24, v25
    v_cvt_pk_bf16_f32 v23, v26, v27
    v_cvt_f32_i32 v12, v110
    s_add_u32 s54, s49, 2469888
    buffer_load_dwordx4 v[168:171], v1, s[20:23], s54 offen
    v_cvt_pk_bf16_f32 v12, 0, v12
    v_add_f32 v12, v12, v33
    v_cvt_pk_bf16_f32 v12, 0, v12
    v_mul_f32 v12, v12, v32
    v_cvt_f32_i32 v13, v114
    v_cvt_pk_bf16_f32 v13, 0, v13
    v_add_f32 v13, v13, v33
    v_cvt_pk_bf16_f32 v13, 0, v13
    v_mul_f32 v13, v13, v32
    ds_write_b128 v3, v[20:23] offset:20480
    v_cvt_f32_i32 v14, v118
    v_cvt_pk_bf16_f32 v14, 0, v14
    v_add_f32 v14, v14, v33
    v_cvt_pk_bf16_f32 v14, 0, v14
    v_mul_f32 v14, v14, v32
    s_add_u32 s54, s49, 2488320
    buffer_load_dwordx4 v[172:175], v1, s[20:23], s54 offen
    v_cvt_f32_i32 v15, v122
    v_cvt_pk_bf16_f32 v15, 0, v15
    v_add_f32 v15, v15, v33
    v_cvt_pk_bf16_f32 v15, 0, v15
    v_mul_f32 v15, v15, v32
    v_cvt_f32_i32 v16, v126
    v_cvt_pk_bf16_f32 v16, 0, v16
    v_add_f32 v16, v16, v33
    v_cvt_pk_bf16_f32 v16, 0, v16
    v_mul_f32 v16, v16, v32
    v_cvt_f32_i32 v17, v130
    v_cvt_pk_bf16_f32 v17, 0, v17
    v_add_f32 v17, v17, v33
    v_cvt_pk_bf16_f32 v17, 0, v17
    v_mul_f32 v17, v17, v32
    s_add_u32 s55, s49, 2359296
    buffer_load_dword v176, v2, s[20:23], s55 offen
    v_cvt_f32_i32 v18, v134
    v_cvt_pk_bf16_f32 v18, 0, v18
    v_add_f32 v18, v18, v33
    v_cvt_pk_bf16_f32 v18, 0, v18
    v_mul_f32 v18, v18, v32
    v_cvt_f32_i32 v19, v138
    v_cvt_pk_bf16_f32 v19, 0, v19
    v_add_f32 v19, v19, v33
    v_cvt_pk_bf16_f32 v19, 0, v19
    v_mul_f32 v19, v19, v32
    v_cvt_pk_bf16_f32 v12, v12, v13
    v_cvt_pk_bf16_f32 v13, v14, v15
    v_cvt_pk_bf16_f32 v14, v16, v17
    v_cvt_pk_bf16_f32 v15, v18, v19
    v_cvt_f32_i32 v20, v111
    s_add_u32 s55, s49, 2377728
    buffer_load_dword v177, v2, s[20:23], s55 offen
    v_cvt_pk_bf16_f32 v20, 0, v20
    v_add_f32 v20, v20, v35
    v_cvt_pk_bf16_f32 v20, 0, v20
    v_mul_f32 v20, v20, v34
    v_cvt_f32_i32 v21, v115
    v_cvt_pk_bf16_f32 v21, 0, v21
    v_add_f32 v21, v21, v35
    v_cvt_pk_bf16_f32 v21, 0, v21
    v_mul_f32 v21, v21, v34
    ds_write_b128 v3, v[12:15] offset:22528
    v_cvt_f32_i32 v22, v119
    v_cvt_pk_bf16_f32 v22, 0, v22
    v_add_f32 v22, v22, v35
    v_cvt_pk_bf16_f32 v22, 0, v22
    v_mul_f32 v22, v22, v34
    s_add_u32 s55, s49, 2396160
    buffer_load_dword v178, v2, s[20:23], s55 offen
    v_cvt_f32_i32 v23, v123
    v_cvt_pk_bf16_f32 v23, 0, v23
    v_add_f32 v23, v23, v35
    v_cvt_pk_bf16_f32 v23, 0, v23
    v_mul_f32 v23, v23, v34
    v_cvt_f32_i32 v24, v127
    v_cvt_pk_bf16_f32 v24, 0, v24
    v_add_f32 v24, v24, v35
    v_cvt_pk_bf16_f32 v24, 0, v24
    v_mul_f32 v24, v24, v34
    v_cvt_f32_i32 v25, v131
    v_cvt_pk_bf16_f32 v25, 0, v25
    v_add_f32 v25, v25, v35
    v_cvt_pk_bf16_f32 v25, 0, v25
    v_mul_f32 v25, v25, v34
    s_add_u32 s55, s49, 2414592
    buffer_load_dword v179, v2, s[20:23], s55 offen
    v_cvt_f32_i32 v26, v135
    v_cvt_pk_bf16_f32 v26, 0, v26
    v_add_f32 v26, v26, v35
    v_cvt_pk_bf16_f32 v26, 0, v26
    v_mul_f32 v26, v26, v34
    v_cvt_f32_i32 v27, v139
    v_cvt_pk_bf16_f32 v27, 0, v27
    v_add_f32 v27, v27, v35
    v_cvt_pk_bf16_f32 v27, 0, v27
    v_mul_f32 v27, v27, v34
    v_cvt_pk_bf16_f32 v20, v20, v21
    v_cvt_pk_bf16_f32 v21, v22, v23
    v_cvt_pk_bf16_f32 v22, v24, v25
    v_cvt_pk_bf16_f32 v23, v26, v27
    v_cvt_f32_i32 v12, v140
    s_add_u32 m0, s39, 16128
    s_nop 0
    buffer_load_dwordx4 v7, s[16:19], s40 offen offset:256 lds
    v_cvt_pk_bf16_f32 v12, 0, v12
    v_add_f32 v12, v12, v37
    v_cvt_pk_bf16_f32 v12, 0, v12
    v_mul_f32 v12, v12, v36
    v_cvt_f32_i32 v13, v141
    v_cvt_pk_bf16_f32 v13, 0, v13
    v_add_f32 v13, v13, v37
    v_cvt_pk_bf16_f32 v13, 0, v13
    v_mul_f32 v13, v13, v36
    ds_write_b128 v3, v[20:23] offset:24576
    v_cvt_f32_i32 v14, v142
    v_cvt_pk_bf16_f32 v14, 0, v14
    v_add_f32 v14, v14, v37
    v_cvt_pk_bf16_f32 v14, 0, v14
    v_mul_f32 v14, v14, v36
    s_add_u32 m0, s39, 17152
    s_nop 0
    buffer_load_dwordx4 v8, s[16:19], s41 offen offset:256 lds
    v_cvt_f32_i32 v15, v143
    v_cvt_pk_bf16_f32 v15, 0, v15
    v_add_f32 v15, v15, v37
    v_cvt_pk_bf16_f32 v15, 0, v15
    v_mul_f32 v15, v15, v36
    v_cvt_pk_bf16_f32 v12, v12, v13
    v_cvt_pk_bf16_f32 v13, v14, v15
    ds_write_b64 v4, v[12:13] offset:34816
    ds_read_b128 v[28:31], v5 offset:39168
    ds_read_b128 v[32:35], v5 offset:39184
    ds_read_b64 v[36:37], v6 offset:40192
    s_waitcnt vmcnt(14) lgkmcnt(3)
    s_barrier
    s_add_u32 m0, s39, 18176
    s_nop 0
    buffer_load_dwordx4 v7, s[16:19], s42 offen offset:256 lds
    s_waitcnt vmcnt(3) lgkmcnt(0)
    v_cvt_f32_i32 v12, v144
    v_cvt_pk_bf16_f32 v12, 0, v12
    v_add_f32 v12, v12, v29
    v_cvt_pk_bf16_f32 v12, 0, v12
    v_mul_f32 v12, v12, v28
    v_cvt_f32_i32 v13, v148
    v_cvt_pk_bf16_f32 v13, 0, v13
    v_add_f32 v13, v13, v29
    v_cvt_pk_bf16_f32 v13, 0, v13
    v_mul_f32 v13, v13, v28
    v_cvt_f32_i32 v14, v152
    v_cvt_pk_bf16_f32 v14, 0, v14
    v_add_f32 v14, v14, v29
    v_cvt_pk_bf16_f32 v14, 0, v14
    v_mul_f32 v14, v14, v28
    s_add_u32 m0, s39, 19200
    s_nop 0
    buffer_load_dwordx4 v8, s[16:19], s43 offen offset:256 lds
    v_cvt_f32_i32 v15, v156
    v_cvt_pk_bf16_f32 v15, 0, v15
    v_add_f32 v15, v15, v29
    v_cvt_pk_bf16_f32 v15, 0, v15
    v_mul_f32 v15, v15, v28
    v_cvt_f32_i32 v16, v160
    v_cvt_pk_bf16_f32 v16, 0, v16
    v_add_f32 v16, v16, v29
    v_cvt_pk_bf16_f32 v16, 0, v16
    v_mul_f32 v16, v16, v28
    v_cvt_f32_i32 v17, v164
    v_cvt_pk_bf16_f32 v17, 0, v17
    v_add_f32 v17, v17, v29
    v_cvt_pk_bf16_f32 v17, 0, v17
    v_mul_f32 v17, v17, v28
    s_add_u32 m0, s39, 20224
    s_nop 0
    buffer_load_dwordx4 v7, s[16:19], s44 offen offset:256 lds
    v_cvt_f32_i32 v18, v168
    v_cvt_pk_bf16_f32 v18, 0, v18
    v_add_f32 v18, v18, v29
    v_cvt_pk_bf16_f32 v18, 0, v18
    v_mul_f32 v18, v18, v28
    v_cvt_f32_i32 v19, v172
    v_cvt_pk_bf16_f32 v19, 0, v19
    v_add_f32 v19, v19, v29
    v_cvt_pk_bf16_f32 v19, 0, v19
    v_mul_f32 v19, v19, v28
    v_cvt_pk_bf16_f32 v12, v12, v13
    v_cvt_pk_bf16_f32 v13, v14, v15
    v_cvt_pk_bf16_f32 v14, v16, v17
    v_cvt_pk_bf16_f32 v15, v18, v19
    v_cvt_f32_i32 v20, v145
    s_add_u32 m0, s39, 21248
    s_nop 0
    buffer_load_dwordx4 v8, s[16:19], s45 offen offset:256 lds
    v_cvt_pk_bf16_f32 v20, 0, v20
    v_add_f32 v20, v20, v31
    v_cvt_pk_bf16_f32 v20, 0, v20
    v_mul_f32 v20, v20, v30
    v_cvt_f32_i32 v21, v149
    v_cvt_pk_bf16_f32 v21, 0, v21
    v_add_f32 v21, v21, v31
    v_cvt_pk_bf16_f32 v21, 0, v21
    v_mul_f32 v21, v21, v30
    ds_write_b128 v3, v[12:15] offset:0
    v_cvt_f32_i32 v22, v153
    v_cvt_pk_bf16_f32 v22, 0, v22
    v_add_f32 v22, v22, v31
    v_cvt_pk_bf16_f32 v22, 0, v22
    v_mul_f32 v22, v22, v30
    s_add_u32 m0, s39, 22272
    s_nop 0
    buffer_load_dwordx4 v7, s[16:19], s46 offen offset:256 lds
    v_cvt_f32_i32 v23, v157
    v_cvt_pk_bf16_f32 v23, 0, v23
    v_add_f32 v23, v23, v31
    v_cvt_pk_bf16_f32 v23, 0, v23
    v_mul_f32 v23, v23, v30
    v_cvt_f32_i32 v24, v161
    v_cvt_pk_bf16_f32 v24, 0, v24
    v_add_f32 v24, v24, v31
    v_cvt_pk_bf16_f32 v24, 0, v24
    v_mul_f32 v24, v24, v30
    v_cvt_f32_i32 v25, v165
    v_cvt_pk_bf16_f32 v25, 0, v25
    v_add_f32 v25, v25, v31
    v_cvt_pk_bf16_f32 v25, 0, v25
    v_mul_f32 v25, v25, v30
    s_add_u32 m0, s39, 23296
    s_nop 0
    buffer_load_dwordx4 v8, s[16:19], s47 offen offset:256 lds
    v_cvt_f32_i32 v26, v169
    v_cvt_pk_bf16_f32 v26, 0, v26
    v_add_f32 v26, v26, v31
    v_cvt_pk_bf16_f32 v26, 0, v26
    v_mul_f32 v26, v26, v30
    v_cvt_f32_i32 v27, v173
    v_cvt_pk_bf16_f32 v27, 0, v27
    v_add_f32 v27, v27, v31
    v_cvt_pk_bf16_f32 v27, 0, v27
    v_mul_f32 v27, v27, v30
    v_cvt_pk_bf16_f32 v20, v20, v21
    v_cvt_pk_bf16_f32 v21, v22, v23
    v_cvt_pk_bf16_f32 v22, v24, v25
    v_cvt_pk_bf16_f32 v23, v26, v27
    v_cvt_f32_i32 v12, v146
    s_add_u32 s54, s49, 3538944
    buffer_load_dwordx4 v[72:75], v1, s[20:23], s54 offen
    v_cvt_pk_bf16_f32 v12, 0, v12
    v_add_f32 v12, v12, v33
    v_cvt_pk_bf16_f32 v12, 0, v12
    v_mul_f32 v12, v12, v32
    v_cvt_f32_i32 v13, v150
    v_cvt_pk_bf16_f32 v13, 0, v13
    v_add_f32 v13, v13, v33
    v_cvt_pk_bf16_f32 v13, 0, v13
    v_mul_f32 v13, v13, v32
    ds_write_b128 v3, v[20:23] offset:2048
    v_cvt_f32_i32 v14, v154
    v_cvt_pk_bf16_f32 v14, 0, v14
    v_add_f32 v14, v14, v33
    v_cvt_pk_bf16_f32 v14, 0, v14
    v_mul_f32 v14, v14, v32
    s_add_u32 s54, s49, 3557376
    buffer_load_dwordx4 v[76:79], v1, s[20:23], s54 offen
    v_cvt_f32_i32 v15, v158
    v_cvt_pk_bf16_f32 v15, 0, v15
    v_add_f32 v15, v15, v33
    v_cvt_pk_bf16_f32 v15, 0, v15
    v_mul_f32 v15, v15, v32
    v_cvt_f32_i32 v16, v162
    v_cvt_pk_bf16_f32 v16, 0, v16
    v_add_f32 v16, v16, v33
    v_cvt_pk_bf16_f32 v16, 0, v16
    v_mul_f32 v16, v16, v32
    v_cvt_f32_i32 v17, v166
    v_cvt_pk_bf16_f32 v17, 0, v17
    v_add_f32 v17, v17, v33
    v_cvt_pk_bf16_f32 v17, 0, v17
    v_mul_f32 v17, v17, v32
    s_add_u32 s54, s49, 3575808
    buffer_load_dwordx4 v[80:83], v1, s[20:23], s54 offen
    v_cvt_f32_i32 v18, v170
    v_cvt_pk_bf16_f32 v18, 0, v18
    v_add_f32 v18, v18, v33
    v_cvt_pk_bf16_f32 v18, 0, v18
    v_mul_f32 v18, v18, v32
    v_cvt_f32_i32 v19, v174
    v_cvt_pk_bf16_f32 v19, 0, v19
    v_add_f32 v19, v19, v33
    v_cvt_pk_bf16_f32 v19, 0, v19
    v_mul_f32 v19, v19, v32
    v_cvt_pk_bf16_f32 v12, v12, v13
    v_cvt_pk_bf16_f32 v13, v14, v15
    v_cvt_pk_bf16_f32 v14, v16, v17
    v_cvt_pk_bf16_f32 v15, v18, v19
    v_cvt_f32_i32 v20, v147
    s_add_u32 s54, s49, 3594240
    buffer_load_dwordx4 v[84:87], v1, s[20:23], s54 offen
    v_cvt_pk_bf16_f32 v20, 0, v20
    v_add_f32 v20, v20, v35
    v_cvt_pk_bf16_f32 v20, 0, v20
    v_mul_f32 v20, v20, v34
    v_cvt_f32_i32 v21, v151
    v_cvt_pk_bf16_f32 v21, 0, v21
    v_add_f32 v21, v21, v35
    v_cvt_pk_bf16_f32 v21, 0, v21
    v_mul_f32 v21, v21, v34
    ds_write_b128 v3, v[12:15] offset:4096
    v_cvt_f32_i32 v22, v155
    v_cvt_pk_bf16_f32 v22, 0, v22
    v_add_f32 v22, v22, v35
    v_cvt_pk_bf16_f32 v22, 0, v22
    v_mul_f32 v22, v22, v34
    s_add_u32 s54, s49, 3612672
    buffer_load_dwordx4 v[88:91], v1, s[20:23], s54 offen
    v_cvt_f32_i32 v23, v159
    v_cvt_pk_bf16_f32 v23, 0, v23
    v_add_f32 v23, v23, v35
    v_cvt_pk_bf16_f32 v23, 0, v23
    v_mul_f32 v23, v23, v34
    v_cvt_f32_i32 v24, v163
    v_cvt_pk_bf16_f32 v24, 0, v24
    v_add_f32 v24, v24, v35
    v_cvt_pk_bf16_f32 v24, 0, v24
    v_mul_f32 v24, v24, v34
    v_cvt_f32_i32 v25, v167
    v_cvt_pk_bf16_f32 v25, 0, v25
    v_add_f32 v25, v25, v35
    v_cvt_pk_bf16_f32 v25, 0, v25
    v_mul_f32 v25, v25, v34
    s_add_u32 s54, s49, 3631104
    buffer_load_dwordx4 v[92:95], v1, s[20:23], s54 offen
    v_cvt_f32_i32 v26, v171
    v_cvt_pk_bf16_f32 v26, 0, v26
    v_add_f32 v26, v26, v35
    v_cvt_pk_bf16_f32 v26, 0, v26
    v_mul_f32 v26, v26, v34
    v_cvt_f32_i32 v27, v175
    v_cvt_pk_bf16_f32 v27, 0, v27
    v_add_f32 v27, v27, v35
    v_cvt_pk_bf16_f32 v27, 0, v27
    v_mul_f32 v27, v27, v34
    v_cvt_pk_bf16_f32 v20, v20, v21
    v_cvt_pk_bf16_f32 v21, v22, v23
    v_cvt_pk_bf16_f32 v22, v24, v25
    v_cvt_pk_bf16_f32 v23, v26, v27
    v_cvt_f32_i32 v12, v176
    s_add_u32 s54, s49, 3649536
    buffer_load_dwordx4 v[96:99], v1, s[20:23], s54 offen
    v_cvt_pk_bf16_f32 v12, 0, v12
    v_add_f32 v12, v12, v37
    v_cvt_pk_bf16_f32 v12, 0, v12
    v_mul_f32 v12, v12, v36
    v_cvt_f32_i32 v13, v177
    v_cvt_pk_bf16_f32 v13, 0, v13
    v_add_f32 v13, v13, v37
    v_cvt_pk_bf16_f32 v13, 0, v13
    v_mul_f32 v13, v13, v36
    ds_write_b128 v3, v[20:23] offset:6144
    v_cvt_f32_i32 v14, v178
    v_cvt_pk_bf16_f32 v14, 0, v14
    v_add_f32 v14, v14, v37
    v_cvt_pk_bf16_f32 v14, 0, v14
    v_mul_f32 v14, v14, v36
    s_add_u32 s54, s49, 3667968
    buffer_load_dwordx4 v[100:103], v1, s[20:23], s54 offen
    v_cvt_f32_i32 v15, v179
    v_cvt_pk_bf16_f32 v15, 0, v15
    v_add_f32 v15, v15, v37
    v_cvt_pk_bf16_f32 v15, 0, v15
    v_mul_f32 v15, v15, v36
    v_cvt_pk_bf16_f32 v12, v12, v13
    v_cvt_pk_bf16_f32 v13, v14, v15
    ds_write_b64 v4, v[12:13] offset:16384
    ds_read_b128 v[28:31], v5 offset:40320
    ds_read_b128 v[32:35], v5 offset:40336
    ds_read_b64 v[36:37], v6 offset:41344
    s_waitcnt vmcnt(8) lgkmcnt(3)
    s_barrier
    s_add_u32 s55, s49, 3538944
    buffer_load_dword v104, v2, s[20:23], s55 offen
    s_add_u32 s55, s49, 3557376
    buffer_load_dword v105, v2, s[20:23], s55 offen
    s_add_u32 s55, s49, 3575808
    buffer_load_dword v106, v2, s[20:23], s55 offen
    s_add_u32 s55, s49, 3594240
    buffer_load_dword v107, v2, s[20:23], s55 offen
    s_sub_u32 m0, s39, 384
    s_nop 0
    buffer_load_dwordx4 v7, s[16:19], s40 offen offset:384 lds
    s_waitcnt vmcnt(1) lgkmcnt(0)
    v_cvt_f32_i32 v12, v72
    v_cvt_pk_bf16_f32 v12, 0, v12
    v_add_f32 v12, v12, v29
    v_cvt_pk_bf16_f32 v12, 0, v12
    v_mul_f32 v12, v12, v28
    v_cvt_f32_i32 v13, v76
    v_cvt_pk_bf16_f32 v13, 0, v13
    v_add_f32 v13, v13, v29
    v_cvt_pk_bf16_f32 v13, 0, v13
    v_mul_f32 v13, v13, v28
    v_cvt_f32_i32 v14, v80
    v_cvt_pk_bf16_f32 v14, 0, v14
    v_add_f32 v14, v14, v29
    v_cvt_pk_bf16_f32 v14, 0, v14
    v_mul_f32 v14, v14, v28
    s_add_u32 m0, s39, 640
    s_nop 0
    buffer_load_dwordx4 v8, s[16:19], s41 offen offset:384 lds
    v_cvt_f32_i32 v15, v84
    v_cvt_pk_bf16_f32 v15, 0, v15
    v_add_f32 v15, v15, v29
    v_cvt_pk_bf16_f32 v15, 0, v15
    v_mul_f32 v15, v15, v28
    v_cvt_f32_i32 v16, v88
    v_cvt_pk_bf16_f32 v16, 0, v16
    v_add_f32 v16, v16, v29
    v_cvt_pk_bf16_f32 v16, 0, v16
    v_mul_f32 v16, v16, v28
    v_cvt_f32_i32 v17, v92
    v_cvt_pk_bf16_f32 v17, 0, v17
    v_add_f32 v17, v17, v29
    v_cvt_pk_bf16_f32 v17, 0, v17
    v_mul_f32 v17, v17, v28
    s_add_u32 m0, s39, 1664
    s_nop 0
    buffer_load_dwordx4 v7, s[16:19], s42 offen offset:384 lds
    v_cvt_f32_i32 v18, v96
    v_cvt_pk_bf16_f32 v18, 0, v18
    v_add_f32 v18, v18, v29
    v_cvt_pk_bf16_f32 v18, 0, v18
    v_mul_f32 v18, v18, v28
    v_cvt_f32_i32 v19, v100
    v_cvt_pk_bf16_f32 v19, 0, v19
    v_add_f32 v19, v19, v29
    v_cvt_pk_bf16_f32 v19, 0, v19
    v_mul_f32 v19, v19, v28
    v_cvt_pk_bf16_f32 v12, v12, v13
    v_cvt_pk_bf16_f32 v13, v14, v15
    v_cvt_pk_bf16_f32 v14, v16, v17
    v_cvt_pk_bf16_f32 v15, v18, v19
    v_cvt_f32_i32 v20, v73
    s_add_u32 m0, s39, 2688
    s_nop 0
    buffer_load_dwordx4 v8, s[16:19], s43 offen offset:384 lds
    v_cvt_pk_bf16_f32 v20, 0, v20
    v_add_f32 v20, v20, v31
    v_cvt_pk_bf16_f32 v20, 0, v20
    v_mul_f32 v20, v20, v30
    v_cvt_f32_i32 v21, v77
    v_cvt_pk_bf16_f32 v21, 0, v21
    v_add_f32 v21, v21, v31
    v_cvt_pk_bf16_f32 v21, 0, v21
    v_mul_f32 v21, v21, v30
    ds_write_b128 v3, v[12:15] offset:18432
    v_cvt_f32_i32 v22, v81
    v_cvt_pk_bf16_f32 v22, 0, v22
    v_add_f32 v22, v22, v31
    v_cvt_pk_bf16_f32 v22, 0, v22
    v_mul_f32 v22, v22, v30
    s_add_u32 m0, s39, 3712
    s_nop 0
    buffer_load_dwordx4 v7, s[16:19], s44 offen offset:384 lds
    v_cvt_f32_i32 v23, v85
    v_cvt_pk_bf16_f32 v23, 0, v23
    v_add_f32 v23, v23, v31
    v_cvt_pk_bf16_f32 v23, 0, v23
    v_mul_f32 v23, v23, v30
    v_cvt_f32_i32 v24, v89
    v_cvt_pk_bf16_f32 v24, 0, v24
    v_add_f32 v24, v24, v31
    v_cvt_pk_bf16_f32 v24, 0, v24
    v_mul_f32 v24, v24, v30
    v_cvt_f32_i32 v25, v93
    v_cvt_pk_bf16_f32 v25, 0, v25
    v_add_f32 v25, v25, v31
    v_cvt_pk_bf16_f32 v25, 0, v25
    v_mul_f32 v25, v25, v30
    s_add_u32 m0, s39, 4736
    s_nop 0
    buffer_load_dwordx4 v8, s[16:19], s45 offen offset:384 lds
    v_cvt_f32_i32 v26, v97
    v_cvt_pk_bf16_f32 v26, 0, v26
    v_add_f32 v26, v26, v31
    v_cvt_pk_bf16_f32 v26, 0, v26
    v_mul_f32 v26, v26, v30
    v_cvt_f32_i32 v27, v101
    v_cvt_pk_bf16_f32 v27, 0, v27
    v_add_f32 v27, v27, v31
    v_cvt_pk_bf16_f32 v27, 0, v27
    v_mul_f32 v27, v27, v30
    v_cvt_pk_bf16_f32 v20, v20, v21
    v_cvt_pk_bf16_f32 v21, v22, v23
    v_cvt_pk_bf16_f32 v22, v24, v25
    v_cvt_pk_bf16_f32 v23, v26, v27
    v_cvt_f32_i32 v12, v74
    s_add_u32 m0, s39, 5760
    s_nop 0
    buffer_load_dwordx4 v7, s[16:19], s46 offen offset:384 lds
    v_cvt_pk_bf16_f32 v12, 0, v12
    v_add_f32 v12, v12, v33
    v_cvt_pk_bf16_f32 v12, 0, v12
    v_mul_f32 v12, v12, v32
    v_cvt_f32_i32 v13, v78
    v_cvt_pk_bf16_f32 v13, 0, v13
    v_add_f32 v13, v13, v33
    v_cvt_pk_bf16_f32 v13, 0, v13
    v_mul_f32 v13, v13, v32
    ds_write_b128 v3, v[20:23] offset:20480
    v_cvt_f32_i32 v14, v82
    v_cvt_pk_bf16_f32 v14, 0, v14
    v_add_f32 v14, v14, v33
    v_cvt_pk_bf16_f32 v14, 0, v14
    v_mul_f32 v14, v14, v32
    s_add_u32 m0, s39, 6784
    s_nop 0
    buffer_load_dwordx4 v8, s[16:19], s47 offen offset:384 lds
    v_cvt_f32_i32 v15, v86
    v_cvt_pk_bf16_f32 v15, 0, v15
    v_add_f32 v15, v15, v33
    v_cvt_pk_bf16_f32 v15, 0, v15
    v_mul_f32 v15, v15, v32
    v_cvt_f32_i32 v16, v90
    v_cvt_pk_bf16_f32 v16, 0, v16
    v_add_f32 v16, v16, v33
    v_cvt_pk_bf16_f32 v16, 0, v16
    v_mul_f32 v16, v16, v32
    v_cvt_f32_i32 v17, v94
    v_cvt_pk_bf16_f32 v17, 0, v17
    v_add_f32 v17, v17, v33
    v_cvt_pk_bf16_f32 v17, 0, v17
    v_mul_f32 v17, v17, v32
    s_add_u32 s54, s49, 4718592
    buffer_load_dwordx4 v[108:111], v1, s[20:23], s54 offen
    v_cvt_f32_i32 v18, v98
    v_cvt_pk_bf16_f32 v18, 0, v18
    v_add_f32 v18, v18, v33
    v_cvt_pk_bf16_f32 v18, 0, v18
    v_mul_f32 v18, v18, v32
    v_cvt_f32_i32 v19, v102
    v_cvt_pk_bf16_f32 v19, 0, v19
    v_add_f32 v19, v19, v33
    v_cvt_pk_bf16_f32 v19, 0, v19
    v_mul_f32 v19, v19, v32
    v_cvt_pk_bf16_f32 v12, v12, v13
    v_cvt_pk_bf16_f32 v13, v14, v15
    v_cvt_pk_bf16_f32 v14, v16, v17
    v_cvt_pk_bf16_f32 v15, v18, v19
    v_cvt_f32_i32 v20, v75
    s_add_u32 s54, s49, 4737024
    buffer_load_dwordx4 v[112:115], v1, s[20:23], s54 offen
    v_cvt_pk_bf16_f32 v20, 0, v20
    v_add_f32 v20, v20, v35
    v_cvt_pk_bf16_f32 v20, 0, v20
    v_mul_f32 v20, v20, v34
    v_cvt_f32_i32 v21, v79
    v_cvt_pk_bf16_f32 v21, 0, v21
    v_add_f32 v21, v21, v35
    v_cvt_pk_bf16_f32 v21, 0, v21
    v_mul_f32 v21, v21, v34
    ds_write_b128 v3, v[12:15] offset:22528
    v_cvt_f32_i32 v22, v83
    v_cvt_pk_bf16_f32 v22, 0, v22
    v_add_f32 v22, v22, v35
    v_cvt_pk_bf16_f32 v22, 0, v22
    v_mul_f32 v22, v22, v34
    s_add_u32 s54, s49, 4755456
    buffer_load_dwordx4 v[116:119], v1, s[20:23], s54 offen
    v_cvt_f32_i32 v23, v87
    v_cvt_pk_bf16_f32 v23, 0, v23
    v_add_f32 v23, v23, v35
    v_cvt_pk_bf16_f32 v23, 0, v23
    v_mul_f32 v23, v23, v34
    v_cvt_f32_i32 v24, v91
    v_cvt_pk_bf16_f32 v24, 0, v24
    v_add_f32 v24, v24, v35
    v_cvt_pk_bf16_f32 v24, 0, v24
    v_mul_f32 v24, v24, v34
    v_cvt_f32_i32 v25, v95
    v_cvt_pk_bf16_f32 v25, 0, v25
    v_add_f32 v25, v25, v35
    v_cvt_pk_bf16_f32 v25, 0, v25
    v_mul_f32 v25, v25, v34
    s_add_u32 s54, s49, 4773888
    buffer_load_dwordx4 v[120:123], v1, s[20:23], s54 offen
    v_cvt_f32_i32 v26, v99
    v_cvt_pk_bf16_f32 v26, 0, v26
    v_add_f32 v26, v26, v35
    v_cvt_pk_bf16_f32 v26, 0, v26
    v_mul_f32 v26, v26, v34
    v_cvt_f32_i32 v27, v103
    v_cvt_pk_bf16_f32 v27, 0, v27
    v_add_f32 v27, v27, v35
    v_cvt_pk_bf16_f32 v27, 0, v27
    v_mul_f32 v27, v27, v34
    v_cvt_pk_bf16_f32 v20, v20, v21
    v_cvt_pk_bf16_f32 v21, v22, v23
    v_cvt_pk_bf16_f32 v22, v24, v25
    v_cvt_pk_bf16_f32 v23, v26, v27
    v_cvt_f32_i32 v12, v104
    s_add_u32 s54, s49, 4792320
    buffer_load_dwordx4 v[124:127], v1, s[20:23], s54 offen
    v_cvt_pk_bf16_f32 v12, 0, v12
    v_add_f32 v12, v12, v37
    v_cvt_pk_bf16_f32 v12, 0, v12
    v_mul_f32 v12, v12, v36
    v_cvt_f32_i32 v13, v105
    v_cvt_pk_bf16_f32 v13, 0, v13
    v_add_f32 v13, v13, v37
    v_cvt_pk_bf16_f32 v13, 0, v13
    v_mul_f32 v13, v13, v36
    ds_write_b128 v3, v[20:23] offset:24576
    v_cvt_f32_i32 v14, v106
    v_cvt_pk_bf16_f32 v14, 0, v14
    v_add_f32 v14, v14, v37
    v_cvt_pk_bf16_f32 v14, 0, v14
    v_mul_f32 v14, v14, v36
    s_add_u32 s54, s49, 4810752
    buffer_load_dwordx4 v[128:131], v1, s[20:23], s54 offen
    v_cvt_f32_i32 v15, v107
    v_cvt_pk_bf16_f32 v15, 0, v15
    v_add_f32 v15, v15, v37
    v_cvt_pk_bf16_f32 v15, 0, v15
    v_mul_f32 v15, v15, v36
    v_cvt_pk_bf16_f32 v12, v12, v13
    v_cvt_pk_bf16_f32 v13, v14, v15
    ds_write_b64 v4, v[12:13] offset:34816
    ds_read_b128 v[28:31], v5 offset:41472
    ds_read_b128 v[32:35], v5 offset:41488
    ds_read_b64 v[36:37], v6 offset:42496
    s_waitcnt vmcnt(6) lgkmcnt(3)
    s_barrier
    s_add_u32 s54, s49, 4829184
    buffer_load_dwordx4 v[132:135], v1, s[20:23], s54 offen
    s_add_u32 s54, s49, 4847616
    buffer_load_dwordx4 v[136:139], v1, s[20:23], s54 offen
    s_add_u32 s55, s49, 4718592
    buffer_load_dword v140, v2, s[20:23], s55 offen
    s_add_u32 s55, s49, 4737024
    buffer_load_dword v141, v2, s[20:23], s55 offen
    s_add_u32 s55, s49, 4755456
    buffer_load_dword v142, v2, s[20:23], s55 offen
    s_add_u32 s55, s49, 4773888
    buffer_load_dword v143, v2, s[20:23], s55 offen
    s_add_u32 m0, s39, 7680
    s_nop 0
    buffer_load_dwordx4 v7, s[16:19], s40 offen offset:512 lds
    s_waitcnt vmcnt(1) lgkmcnt(0)
    v_cvt_f32_i32 v12, v108
    v_cvt_pk_bf16_f32 v12, 0, v12
    v_add_f32 v12, v12, v29
    v_cvt_pk_bf16_f32 v12, 0, v12
    v_mul_f32 v12, v12, v28
    v_cvt_f32_i32 v13, v112
    v_cvt_pk_bf16_f32 v13, 0, v13
    v_add_f32 v13, v13, v29
    v_cvt_pk_bf16_f32 v13, 0, v13
    v_mul_f32 v13, v13, v28
    v_cvt_f32_i32 v14, v116
    v_cvt_pk_bf16_f32 v14, 0, v14
    v_add_f32 v14, v14, v29
    v_cvt_pk_bf16_f32 v14, 0, v14
    v_mul_f32 v14, v14, v28
    s_add_u32 m0, s39, 8704
    s_nop 0
    buffer_load_dwordx4 v8, s[16:19], s41 offen offset:512 lds
    v_cvt_f32_i32 v15, v120
    v_cvt_pk_bf16_f32 v15, 0, v15
    v_add_f32 v15, v15, v29
    v_cvt_pk_bf16_f32 v15, 0, v15
    v_mul_f32 v15, v15, v28
    v_cvt_f32_i32 v16, v124
    v_cvt_pk_bf16_f32 v16, 0, v16
    v_add_f32 v16, v16, v29
    v_cvt_pk_bf16_f32 v16, 0, v16
    v_mul_f32 v16, v16, v28
    v_cvt_f32_i32 v17, v128
    v_cvt_pk_bf16_f32 v17, 0, v17
    v_add_f32 v17, v17, v29
    v_cvt_pk_bf16_f32 v17, 0, v17
    v_mul_f32 v17, v17, v28
    s_add_u32 m0, s39, 9728
    s_nop 0
    buffer_load_dwordx4 v7, s[16:19], s42 offen offset:512 lds
    v_cvt_f32_i32 v18, v132
    v_cvt_pk_bf16_f32 v18, 0, v18
    v_add_f32 v18, v18, v29
    v_cvt_pk_bf16_f32 v18, 0, v18
    v_mul_f32 v18, v18, v28
    v_cvt_f32_i32 v19, v136
    v_cvt_pk_bf16_f32 v19, 0, v19
    v_add_f32 v19, v19, v29
    v_cvt_pk_bf16_f32 v19, 0, v19
    v_mul_f32 v19, v19, v28
    v_cvt_pk_bf16_f32 v12, v12, v13
    v_cvt_pk_bf16_f32 v13, v14, v15
    v_cvt_pk_bf16_f32 v14, v16, v17
    v_cvt_pk_bf16_f32 v15, v18, v19
    v_cvt_f32_i32 v20, v109
    s_add_u32 m0, s39, 10752
    s_nop 0
    buffer_load_dwordx4 v8, s[16:19], s43 offen offset:512 lds
    v_cvt_pk_bf16_f32 v20, 0, v20
    v_add_f32 v20, v20, v31
    v_cvt_pk_bf16_f32 v20, 0, v20
    v_mul_f32 v20, v20, v30
    v_cvt_f32_i32 v21, v113
    v_cvt_pk_bf16_f32 v21, 0, v21
    v_add_f32 v21, v21, v31
    v_cvt_pk_bf16_f32 v21, 0, v21
    v_mul_f32 v21, v21, v30
    ds_write_b128 v3, v[12:15] offset:0
    v_cvt_f32_i32 v22, v117
    v_cvt_pk_bf16_f32 v22, 0, v22
    v_add_f32 v22, v22, v31
    v_cvt_pk_bf16_f32 v22, 0, v22
    v_mul_f32 v22, v22, v30
    s_add_u32 m0, s39, 11776
    s_nop 0
    buffer_load_dwordx4 v7, s[16:19], s44 offen offset:512 lds
    v_cvt_f32_i32 v23, v121
    v_cvt_pk_bf16_f32 v23, 0, v23
    v_add_f32 v23, v23, v31
    v_cvt_pk_bf16_f32 v23, 0, v23
    v_mul_f32 v23, v23, v30
    v_cvt_f32_i32 v24, v125
    v_cvt_pk_bf16_f32 v24, 0, v24
    v_add_f32 v24, v24, v31
    v_cvt_pk_bf16_f32 v24, 0, v24
    v_mul_f32 v24, v24, v30
    v_cvt_f32_i32 v25, v129
    v_cvt_pk_bf16_f32 v25, 0, v25
    v_add_f32 v25, v25, v31
    v_cvt_pk_bf16_f32 v25, 0, v25
    v_mul_f32 v25, v25, v30
    s_add_u32 m0, s39, 12800
    s_nop 0
    buffer_load_dwordx4 v8, s[16:19], s45 offen offset:512 lds
    v_cvt_f32_i32 v26, v133
    v_cvt_pk_bf16_f32 v26, 0, v26
    v_add_f32 v26, v26, v31
    v_cvt_pk_bf16_f32 v26, 0, v26
    v_mul_f32 v26, v26, v30
    v_cvt_f32_i32 v27, v137
    v_cvt_pk_bf16_f32 v27, 0, v27
    v_add_f32 v27, v27, v31
    v_cvt_pk_bf16_f32 v27, 0, v27
    v_mul_f32 v27, v27, v30
    v_cvt_pk_bf16_f32 v20, v20, v21
    v_cvt_pk_bf16_f32 v21, v22, v23
    v_cvt_pk_bf16_f32 v22, v24, v25
    v_cvt_pk_bf16_f32 v23, v26, v27
    v_cvt_f32_i32 v12, v110
    s_add_u32 m0, s39, 13824
    s_nop 0
    buffer_load_dwordx4 v7, s[16:19], s46 offen offset:512 lds
    v_cvt_pk_bf16_f32 v12, 0, v12
    v_add_f32 v12, v12, v33
    v_cvt_pk_bf16_f32 v12, 0, v12
    v_mul_f32 v12, v12, v32
    v_cvt_f32_i32 v13, v114
    v_cvt_pk_bf16_f32 v13, 0, v13
    v_add_f32 v13, v13, v33
    v_cvt_pk_bf16_f32 v13, 0, v13
    v_mul_f32 v13, v13, v32
    ds_write_b128 v3, v[20:23] offset:2048
    v_cvt_f32_i32 v14, v118
    v_cvt_pk_bf16_f32 v14, 0, v14
    v_add_f32 v14, v14, v33
    v_cvt_pk_bf16_f32 v14, 0, v14
    v_mul_f32 v14, v14, v32
    s_add_u32 m0, s39, 14848
    s_nop 0
    buffer_load_dwordx4 v8, s[16:19], s47 offen offset:512 lds
    v_cvt_f32_i32 v15, v122
    v_cvt_pk_bf16_f32 v15, 0, v15
    v_add_f32 v15, v15, v33
    v_cvt_pk_bf16_f32 v15, 0, v15
    v_mul_f32 v15, v15, v32
    v_cvt_f32_i32 v16, v126
    v_cvt_pk_bf16_f32 v16, 0, v16
    v_add_f32 v16, v16, v33
    v_cvt_pk_bf16_f32 v16, 0, v16
    v_mul_f32 v16, v16, v32
    v_cvt_f32_i32 v17, v130
    v_cvt_pk_bf16_f32 v17, 0, v17
    v_add_f32 v17, v17, v33
    v_cvt_pk_bf16_f32 v17, 0, v17
    v_mul_f32 v17, v17, v32
    s_add_u32 s54, s49, 5898240
    buffer_load_dwordx4 v[144:147], v1, s[20:23], s54 offen
    v_cvt_f32_i32 v18, v134
    v_cvt_pk_bf16_f32 v18, 0, v18
    v_add_f32 v18, v18, v33
    v_cvt_pk_bf16_f32 v18, 0, v18
    v_mul_f32 v18, v18, v32
    v_cvt_f32_i32 v19, v138
    v_cvt_pk_bf16_f32 v19, 0, v19
    v_add_f32 v19, v19, v33
    v_cvt_pk_bf16_f32 v19, 0, v19
    v_mul_f32 v19, v19, v32
    v_cvt_pk_bf16_f32 v12, v12, v13
    v_cvt_pk_bf16_f32 v13, v14, v15
    v_cvt_pk_bf16_f32 v14, v16, v17
    v_cvt_pk_bf16_f32 v15, v18, v19
    v_cvt_f32_i32 v20, v111
    s_add_u32 s54, s49, 5916672
    buffer_load_dwordx4 v[148:151], v1, s[20:23], s54 offen
    v_cvt_pk_bf16_f32 v20, 0, v20
    v_add_f32 v20, v20, v35
    v_cvt_pk_bf16_f32 v20, 0, v20
    v_mul_f32 v20, v20, v34
    v_cvt_f32_i32 v21, v115
    v_cvt_pk_bf16_f32 v21, 0, v21
    v_add_f32 v21, v21, v35
    v_cvt_pk_bf16_f32 v21, 0, v21
    v_mul_f32 v21, v21, v34
    ds_write_b128 v3, v[12:15] offset:4096
    v_cvt_f32_i32 v22, v119
    v_cvt_pk_bf16_f32 v22, 0, v22
    v_add_f32 v22, v22, v35
    v_cvt_pk_bf16_f32 v22, 0, v22
    v_mul_f32 v22, v22, v34
    s_add_u32 s54, s49, 5935104
    buffer_load_dwordx4 v[152:155], v1, s[20:23], s54 offen
    v_cvt_f32_i32 v23, v123
    v_cvt_pk_bf16_f32 v23, 0, v23
    v_add_f32 v23, v23, v35
    v_cvt_pk_bf16_f32 v23, 0, v23
    v_mul_f32 v23, v23, v34
    v_cvt_f32_i32 v24, v127
    v_cvt_pk_bf16_f32 v24, 0, v24
    v_add_f32 v24, v24, v35
    v_cvt_pk_bf16_f32 v24, 0, v24
    v_mul_f32 v24, v24, v34
    v_cvt_f32_i32 v25, v131
    v_cvt_pk_bf16_f32 v25, 0, v25
    v_add_f32 v25, v25, v35
    v_cvt_pk_bf16_f32 v25, 0, v25
    v_mul_f32 v25, v25, v34
    s_add_u32 s54, s49, 5953536
    buffer_load_dwordx4 v[156:159], v1, s[20:23], s54 offen
    v_cvt_f32_i32 v26, v135
    v_cvt_pk_bf16_f32 v26, 0, v26
    v_add_f32 v26, v26, v35
    v_cvt_pk_bf16_f32 v26, 0, v26
    v_mul_f32 v26, v26, v34
    v_cvt_f32_i32 v27, v139
    v_cvt_pk_bf16_f32 v27, 0, v27
    v_add_f32 v27, v27, v35
    v_cvt_pk_bf16_f32 v27, 0, v27
    v_mul_f32 v27, v27, v34
    v_cvt_pk_bf16_f32 v20, v20, v21
    v_cvt_pk_bf16_f32 v21, v22, v23
    v_cvt_pk_bf16_f32 v22, v24, v25
    v_cvt_pk_bf16_f32 v23, v26, v27
    v_cvt_f32_i32 v12, v140
    s_add_u32 s54, s49, 5971968
    buffer_load_dwordx4 v[160:163], v1, s[20:23], s54 offen
    v_cvt_pk_bf16_f32 v12, 0, v12
    v_add_f32 v12, v12, v37
    v_cvt_pk_bf16_f32 v12, 0, v12
    v_mul_f32 v12, v12, v36
    v_cvt_f32_i32 v13, v141
    v_cvt_pk_bf16_f32 v13, 0, v13
    v_add_f32 v13, v13, v37
    v_cvt_pk_bf16_f32 v13, 0, v13
    v_mul_f32 v13, v13, v36
    ds_write_b128 v3, v[20:23] offset:6144
    v_cvt_f32_i32 v14, v142
    v_cvt_pk_bf16_f32 v14, 0, v14
    v_add_f32 v14, v14, v37
    v_cvt_pk_bf16_f32 v14, 0, v14
    v_mul_f32 v14, v14, v36
    s_add_u32 s54, s49, 5990400
    buffer_load_dwordx4 v[164:167], v1, s[20:23], s54 offen
    v_cvt_f32_i32 v15, v143
    v_cvt_pk_bf16_f32 v15, 0, v15
    v_add_f32 v15, v15, v37
    v_cvt_pk_bf16_f32 v15, 0, v15
    v_mul_f32 v15, v15, v36
    v_cvt_pk_bf16_f32 v12, v12, v13
    v_cvt_pk_bf16_f32 v13, v14, v15
    ds_write_b64 v4, v[12:13] offset:16384
    ds_read_b128 v[28:31], v5 offset:42624
    ds_read_b128 v[32:35], v5 offset:42640
    ds_read_b64 v[36:37], v6 offset:43648
    s_waitcnt vmcnt(6) lgkmcnt(3)
    s_barrier
    s_add_u32 s54, s49, 6008832
    buffer_load_dwordx4 v[168:171], v1, s[20:23], s54 offen
    s_add_u32 s54, s49, 6027264
    buffer_load_dwordx4 v[172:175], v1, s[20:23], s54 offen
    s_add_u32 s55, s49, 5898240
    buffer_load_dword v176, v2, s[20:23], s55 offen
    s_add_u32 s55, s49, 5916672
    buffer_load_dword v177, v2, s[20:23], s55 offen
    s_add_u32 s55, s49, 5935104
    buffer_load_dword v178, v2, s[20:23], s55 offen
    s_add_u32 s55, s49, 5953536
    buffer_load_dword v179, v2, s[20:23], s55 offen
    s_add_u32 m0, s39, 15744
    s_nop 0
    buffer_load_dwordx4 v7, s[16:19], s40 offen offset:640 lds
    s_waitcnt vmcnt(1) lgkmcnt(0)
    v_cvt_f32_i32 v12, v144
    v_cvt_pk_bf16_f32 v12, 0, v12
    v_add_f32 v12, v12, v29
    v_cvt_pk_bf16_f32 v12, 0, v12
    v_mul_f32 v12, v12, v28
    v_cvt_f32_i32 v13, v148
    v_cvt_pk_bf16_f32 v13, 0, v13
    v_add_f32 v13, v13, v29
    v_cvt_pk_bf16_f32 v13, 0, v13
    v_mul_f32 v13, v13, v28
    v_cvt_f32_i32 v14, v152
    v_cvt_pk_bf16_f32 v14, 0, v14
    v_add_f32 v14, v14, v29
    v_cvt_pk_bf16_f32 v14, 0, v14
    v_mul_f32 v14, v14, v28
    s_add_u32 m0, s39, 16768
    s_nop 0
    buffer_load_dwordx4 v8, s[16:19], s41 offen offset:640 lds
    v_cvt_f32_i32 v15, v156
    v_cvt_pk_bf16_f32 v15, 0, v15
    v_add_f32 v15, v15, v29
    v_cvt_pk_bf16_f32 v15, 0, v15
    v_mul_f32 v15, v15, v28
    v_cvt_f32_i32 v16, v160
    v_cvt_pk_bf16_f32 v16, 0, v16
    v_add_f32 v16, v16, v29
    v_cvt_pk_bf16_f32 v16, 0, v16
    v_mul_f32 v16, v16, v28
    v_cvt_f32_i32 v17, v164
    v_cvt_pk_bf16_f32 v17, 0, v17
    v_add_f32 v17, v17, v29
    v_cvt_pk_bf16_f32 v17, 0, v17
    v_mul_f32 v17, v17, v28
    s_add_u32 m0, s39, 17792
    s_nop 0
    buffer_load_dwordx4 v7, s[16:19], s42 offen offset:640 lds
    v_cvt_f32_i32 v18, v168
    v_cvt_pk_bf16_f32 v18, 0, v18
    v_add_f32 v18, v18, v29
    v_cvt_pk_bf16_f32 v18, 0, v18
    v_mul_f32 v18, v18, v28
    v_cvt_f32_i32 v19, v172
    v_cvt_pk_bf16_f32 v19, 0, v19
    v_add_f32 v19, v19, v29
    v_cvt_pk_bf16_f32 v19, 0, v19
    v_mul_f32 v19, v19, v28
    v_cvt_pk_bf16_f32 v12, v12, v13
    v_cvt_pk_bf16_f32 v13, v14, v15
    v_cvt_pk_bf16_f32 v14, v16, v17
    v_cvt_pk_bf16_f32 v15, v18, v19
    v_cvt_f32_i32 v20, v145
    s_add_u32 m0, s39, 18816
    s_nop 0
    buffer_load_dwordx4 v8, s[16:19], s43 offen offset:640 lds
    v_cvt_pk_bf16_f32 v20, 0, v20
    v_add_f32 v20, v20, v31
    v_cvt_pk_bf16_f32 v20, 0, v20
    v_mul_f32 v20, v20, v30
    v_cvt_f32_i32 v21, v149
    v_cvt_pk_bf16_f32 v21, 0, v21
    v_add_f32 v21, v21, v31
    v_cvt_pk_bf16_f32 v21, 0, v21
    v_mul_f32 v21, v21, v30
    ds_write_b128 v3, v[12:15] offset:18432
    v_cvt_f32_i32 v22, v153
    v_cvt_pk_bf16_f32 v22, 0, v22
    v_add_f32 v22, v22, v31
    v_cvt_pk_bf16_f32 v22, 0, v22
    v_mul_f32 v22, v22, v30
    s_add_u32 m0, s39, 19840
    s_nop 0
    buffer_load_dwordx4 v7, s[16:19], s44 offen offset:640 lds
    v_cvt_f32_i32 v23, v157
    v_cvt_pk_bf16_f32 v23, 0, v23
    v_add_f32 v23, v23, v31
    v_cvt_pk_bf16_f32 v23, 0, v23
    v_mul_f32 v23, v23, v30
    v_cvt_f32_i32 v24, v161
    v_cvt_pk_bf16_f32 v24, 0, v24
    v_add_f32 v24, v24, v31
    v_cvt_pk_bf16_f32 v24, 0, v24
    v_mul_f32 v24, v24, v30
    v_cvt_f32_i32 v25, v165
    v_cvt_pk_bf16_f32 v25, 0, v25
    v_add_f32 v25, v25, v31
    v_cvt_pk_bf16_f32 v25, 0, v25
    v_mul_f32 v25, v25, v30
    s_add_u32 m0, s39, 20864
    s_nop 0
    buffer_load_dwordx4 v8, s[16:19], s45 offen offset:640 lds
    v_cvt_f32_i32 v26, v169
    v_cvt_pk_bf16_f32 v26, 0, v26
    v_add_f32 v26, v26, v31
    v_cvt_pk_bf16_f32 v26, 0, v26
    v_mul_f32 v26, v26, v30
    v_cvt_f32_i32 v27, v173
    v_cvt_pk_bf16_f32 v27, 0, v27
    v_add_f32 v27, v27, v31
    v_cvt_pk_bf16_f32 v27, 0, v27
    v_mul_f32 v27, v27, v30
    v_cvt_pk_bf16_f32 v20, v20, v21
    v_cvt_pk_bf16_f32 v21, v22, v23
    v_cvt_pk_bf16_f32 v22, v24, v25
    v_cvt_pk_bf16_f32 v23, v26, v27
    v_cvt_f32_i32 v12, v146
    s_add_u32 m0, s39, 21888
    s_nop 0
    buffer_load_dwordx4 v7, s[16:19], s46 offen offset:640 lds
    v_cvt_pk_bf16_f32 v12, 0, v12
    v_add_f32 v12, v12, v33
    v_cvt_pk_bf16_f32 v12, 0, v12
    v_mul_f32 v12, v12, v32
    v_cvt_f32_i32 v13, v150
    v_cvt_pk_bf16_f32 v13, 0, v13
    v_add_f32 v13, v13, v33
    v_cvt_pk_bf16_f32 v13, 0, v13
    v_mul_f32 v13, v13, v32
    ds_write_b128 v3, v[20:23] offset:20480
    v_cvt_f32_i32 v14, v154
    v_cvt_pk_bf16_f32 v14, 0, v14
    v_add_f32 v14, v14, v33
    v_cvt_pk_bf16_f32 v14, 0, v14
    v_mul_f32 v14, v14, v32
    s_add_u32 m0, s39, 22912
    s_nop 0
    buffer_load_dwordx4 v8, s[16:19], s47 offen offset:640 lds
    v_cvt_f32_i32 v15, v158
    v_cvt_pk_bf16_f32 v15, 0, v15
    v_add_f32 v15, v15, v33
    v_cvt_pk_bf16_f32 v15, 0, v15
    v_mul_f32 v15, v15, v32
    v_cvt_f32_i32 v16, v162
    v_cvt_pk_bf16_f32 v16, 0, v16
    v_add_f32 v16, v16, v33
    v_cvt_pk_bf16_f32 v16, 0, v16
    v_mul_f32 v16, v16, v32
    v_cvt_f32_i32 v17, v166
    v_cvt_pk_bf16_f32 v17, 0, v17
    v_add_f32 v17, v17, v33
    v_cvt_pk_bf16_f32 v17, 0, v17
    v_mul_f32 v17, v17, v32
    s_add_u32 s54, s49, 7077888
    buffer_load_dwordx4 v[72:75], v1, s[20:23], s54 offen
    v_cvt_f32_i32 v18, v170
    v_cvt_pk_bf16_f32 v18, 0, v18
    v_add_f32 v18, v18, v33
    v_cvt_pk_bf16_f32 v18, 0, v18
    v_mul_f32 v18, v18, v32
    v_cvt_f32_i32 v19, v174
    v_cvt_pk_bf16_f32 v19, 0, v19
    v_add_f32 v19, v19, v33
    v_cvt_pk_bf16_f32 v19, 0, v19
    v_mul_f32 v19, v19, v32
    v_cvt_pk_bf16_f32 v12, v12, v13
    v_cvt_pk_bf16_f32 v13, v14, v15
    v_cvt_pk_bf16_f32 v14, v16, v17
    v_cvt_pk_bf16_f32 v15, v18, v19
    v_cvt_f32_i32 v20, v147
    s_add_u32 s54, s49, 7096320
    buffer_load_dwordx4 v[76:79], v1, s[20:23], s54 offen
    v_cvt_pk_bf16_f32 v20, 0, v20
    v_add_f32 v20, v20, v35
    v_cvt_pk_bf16_f32 v20, 0, v20
    v_mul_f32 v20, v20, v34
    v_cvt_f32_i32 v21, v151
    v_cvt_pk_bf16_f32 v21, 0, v21
    v_add_f32 v21, v21, v35
    v_cvt_pk_bf16_f32 v21, 0, v21
    v_mul_f32 v21, v21, v34
    ds_write_b128 v3, v[12:15] offset:22528
    v_cvt_f32_i32 v22, v155
    v_cvt_pk_bf16_f32 v22, 0, v22
    v_add_f32 v22, v22, v35
    v_cvt_pk_bf16_f32 v22, 0, v22
    v_mul_f32 v22, v22, v34
    s_add_u32 s54, s49, 7114752
    buffer_load_dwordx4 v[80:83], v1, s[20:23], s54 offen
    v_cvt_f32_i32 v23, v159
    v_cvt_pk_bf16_f32 v23, 0, v23
    v_add_f32 v23, v23, v35
    v_cvt_pk_bf16_f32 v23, 0, v23
    v_mul_f32 v23, v23, v34
    v_cvt_f32_i32 v24, v163
    v_cvt_pk_bf16_f32 v24, 0, v24
    v_add_f32 v24, v24, v35
    v_cvt_pk_bf16_f32 v24, 0, v24
    v_mul_f32 v24, v24, v34
    v_cvt_f32_i32 v25, v167
    v_cvt_pk_bf16_f32 v25, 0, v25
    v_add_f32 v25, v25, v35
    v_cvt_pk_bf16_f32 v25, 0, v25
    v_mul_f32 v25, v25, v34
    s_add_u32 s54, s49, 7133184
    buffer_load_dwordx4 v[84:87], v1, s[20:23], s54 offen
    v_cvt_f32_i32 v26, v171
    v_cvt_pk_bf16_f32 v26, 0, v26
    v_add_f32 v26, v26, v35
    v_cvt_pk_bf16_f32 v26, 0, v26
    v_mul_f32 v26, v26, v34
    v_cvt_f32_i32 v27, v175
    v_cvt_pk_bf16_f32 v27, 0, v27
    v_add_f32 v27, v27, v35
    v_cvt_pk_bf16_f32 v27, 0, v27
    v_mul_f32 v27, v27, v34
    v_cvt_pk_bf16_f32 v20, v20, v21
    v_cvt_pk_bf16_f32 v21, v22, v23
    v_cvt_pk_bf16_f32 v22, v24, v25
    v_cvt_pk_bf16_f32 v23, v26, v27
    v_cvt_f32_i32 v12, v176
    s_add_u32 s54, s49, 7151616
    buffer_load_dwordx4 v[88:91], v1, s[20:23], s54 offen
    v_cvt_pk_bf16_f32 v12, 0, v12
    v_add_f32 v12, v12, v37
    v_cvt_pk_bf16_f32 v12, 0, v12
    v_mul_f32 v12, v12, v36
    v_cvt_f32_i32 v13, v177
    v_cvt_pk_bf16_f32 v13, 0, v13
    v_add_f32 v13, v13, v37
    v_cvt_pk_bf16_f32 v13, 0, v13
    v_mul_f32 v13, v13, v36
    ds_write_b128 v3, v[20:23] offset:24576
    v_cvt_f32_i32 v14, v178
    v_cvt_pk_bf16_f32 v14, 0, v14
    v_add_f32 v14, v14, v37
    v_cvt_pk_bf16_f32 v14, 0, v14
    v_mul_f32 v14, v14, v36
    s_add_u32 s54, s49, 7170048
    buffer_load_dwordx4 v[92:95], v1, s[20:23], s54 offen
    v_cvt_f32_i32 v15, v179
    v_cvt_pk_bf16_f32 v15, 0, v15
    v_add_f32 v15, v15, v37
    v_cvt_pk_bf16_f32 v15, 0, v15
    v_mul_f32 v15, v15, v36
    v_cvt_pk_bf16_f32 v12, v12, v13
    v_cvt_pk_bf16_f32 v13, v14, v15
    ds_write_b64 v4, v[12:13] offset:34816
    ds_read_b128 v[28:31], v5 offset:43776
    ds_read_b128 v[32:35], v5 offset:43792
    ds_read_b64 v[36:37], v6 offset:44800
    s_waitcnt vmcnt(6) lgkmcnt(3)
    s_barrier
    s_add_u32 s54, s49, 7188480
    buffer_load_dwordx4 v[96:99], v1, s[20:23], s54 offen
    s_add_u32 s54, s49, 7206912
    buffer_load_dwordx4 v[100:103], v1, s[20:23], s54 offen
    s_add_u32 s55, s49, 7077888
    buffer_load_dword v104, v2, s[20:23], s55 offen
    s_add_u32 s55, s49, 7096320
    buffer_load_dword v105, v2, s[20:23], s55 offen
    s_add_u32 s55, s49, 7114752
    buffer_load_dword v106, v2, s[20:23], s55 offen
    s_add_u32 s55, s49, 7133184
    buffer_load_dword v107, v2, s[20:23], s55 offen
    s_sub_u32 m0, s39, 768
    s_nop 0
    buffer_load_dwordx4 v7, s[16:19], s40 offen offset:768 lds
    s_waitcnt vmcnt(1) lgkmcnt(0)
    v_cvt_f32_i32 v12, v72
    v_cvt_pk_bf16_f32 v12, 0, v12
    v_add_f32 v12, v12, v29
    v_cvt_pk_bf16_f32 v12, 0, v12
    v_mul_f32 v12, v12, v28
    v_cvt_f32_i32 v13, v76
    v_cvt_pk_bf16_f32 v13, 0, v13
    v_add_f32 v13, v13, v29
    v_cvt_pk_bf16_f32 v13, 0, v13
    v_mul_f32 v13, v13, v28
    v_cvt_f32_i32 v14, v80
    v_cvt_pk_bf16_f32 v14, 0, v14
    v_add_f32 v14, v14, v29
    v_cvt_pk_bf16_f32 v14, 0, v14
    v_mul_f32 v14, v14, v28
    s_add_u32 m0, s39, 256
    s_nop 0
    buffer_load_dwordx4 v8, s[16:19], s41 offen offset:768 lds
    v_cvt_f32_i32 v15, v84
    v_cvt_pk_bf16_f32 v15, 0, v15
    v_add_f32 v15, v15, v29
    v_cvt_pk_bf16_f32 v15, 0, v15
    v_mul_f32 v15, v15, v28
    v_cvt_f32_i32 v16, v88
    v_cvt_pk_bf16_f32 v16, 0, v16
    v_add_f32 v16, v16, v29
    v_cvt_pk_bf16_f32 v16, 0, v16
    v_mul_f32 v16, v16, v28
    v_cvt_f32_i32 v17, v92
    v_cvt_pk_bf16_f32 v17, 0, v17
    v_add_f32 v17, v17, v29
    v_cvt_pk_bf16_f32 v17, 0, v17
    v_mul_f32 v17, v17, v28
    s_add_u32 m0, s39, 1280
    s_nop 0
    buffer_load_dwordx4 v7, s[16:19], s42 offen offset:768 lds
    v_cvt_f32_i32 v18, v96
    v_cvt_pk_bf16_f32 v18, 0, v18
    v_add_f32 v18, v18, v29
    v_cvt_pk_bf16_f32 v18, 0, v18
    v_mul_f32 v18, v18, v28
    v_cvt_f32_i32 v19, v100
    v_cvt_pk_bf16_f32 v19, 0, v19
    v_add_f32 v19, v19, v29
    v_cvt_pk_bf16_f32 v19, 0, v19
    v_mul_f32 v19, v19, v28
    v_cvt_pk_bf16_f32 v12, v12, v13
    v_cvt_pk_bf16_f32 v13, v14, v15
    v_cvt_pk_bf16_f32 v14, v16, v17
    v_cvt_pk_bf16_f32 v15, v18, v19
    v_cvt_f32_i32 v20, v73
    s_add_u32 m0, s39, 2304
    s_nop 0
    buffer_load_dwordx4 v8, s[16:19], s43 offen offset:768 lds
    v_cvt_pk_bf16_f32 v20, 0, v20
    v_add_f32 v20, v20, v31
    v_cvt_pk_bf16_f32 v20, 0, v20
    v_mul_f32 v20, v20, v30
    v_cvt_f32_i32 v21, v77
    v_cvt_pk_bf16_f32 v21, 0, v21
    v_add_f32 v21, v21, v31
    v_cvt_pk_bf16_f32 v21, 0, v21
    v_mul_f32 v21, v21, v30
    ds_write_b128 v3, v[12:15] offset:0
    v_cvt_f32_i32 v22, v81
    v_cvt_pk_bf16_f32 v22, 0, v22
    v_add_f32 v22, v22, v31
    v_cvt_pk_bf16_f32 v22, 0, v22
    v_mul_f32 v22, v22, v30
    s_add_u32 m0, s39, 3328
    s_nop 0
    buffer_load_dwordx4 v7, s[16:19], s44 offen offset:768 lds
    v_cvt_f32_i32 v23, v85
    v_cvt_pk_bf16_f32 v23, 0, v23
    v_add_f32 v23, v23, v31
    v_cvt_pk_bf16_f32 v23, 0, v23
    v_mul_f32 v23, v23, v30
    v_cvt_f32_i32 v24, v89
    v_cvt_pk_bf16_f32 v24, 0, v24
    v_add_f32 v24, v24, v31
    v_cvt_pk_bf16_f32 v24, 0, v24
    v_mul_f32 v24, v24, v30
    v_cvt_f32_i32 v25, v93
    v_cvt_pk_bf16_f32 v25, 0, v25
    v_add_f32 v25, v25, v31
    v_cvt_pk_bf16_f32 v25, 0, v25
    v_mul_f32 v25, v25, v30
    s_add_u32 m0, s39, 4352
    s_nop 0
    buffer_load_dwordx4 v8, s[16:19], s45 offen offset:768 lds
    v_cvt_f32_i32 v26, v97
    v_cvt_pk_bf16_f32 v26, 0, v26
    v_add_f32 v26, v26, v31
    v_cvt_pk_bf16_f32 v26, 0, v26
    v_mul_f32 v26, v26, v30
    v_cvt_f32_i32 v27, v101
    v_cvt_pk_bf16_f32 v27, 0, v27
    v_add_f32 v27, v27, v31
    v_cvt_pk_bf16_f32 v27, 0, v27
    v_mul_f32 v27, v27, v30
    v_cvt_pk_bf16_f32 v20, v20, v21
    v_cvt_pk_bf16_f32 v21, v22, v23
    v_cvt_pk_bf16_f32 v22, v24, v25
    v_cvt_pk_bf16_f32 v23, v26, v27
    v_cvt_f32_i32 v12, v74
    s_add_u32 m0, s39, 5376
    s_nop 0
    buffer_load_dwordx4 v7, s[16:19], s46 offen offset:768 lds
    v_cvt_pk_bf16_f32 v12, 0, v12
    v_add_f32 v12, v12, v33
    v_cvt_pk_bf16_f32 v12, 0, v12
    v_mul_f32 v12, v12, v32
    v_cvt_f32_i32 v13, v78
    v_cvt_pk_bf16_f32 v13, 0, v13
    v_add_f32 v13, v13, v33
    v_cvt_pk_bf16_f32 v13, 0, v13
    v_mul_f32 v13, v13, v32
    ds_write_b128 v3, v[20:23] offset:2048
    v_cvt_f32_i32 v14, v82
    v_cvt_pk_bf16_f32 v14, 0, v14
    v_add_f32 v14, v14, v33
    v_cvt_pk_bf16_f32 v14, 0, v14
    v_mul_f32 v14, v14, v32
    s_add_u32 m0, s39, 6400
    s_nop 0
    buffer_load_dwordx4 v8, s[16:19], s47 offen offset:768 lds
    v_cvt_f32_i32 v15, v86
    v_cvt_pk_bf16_f32 v15, 0, v15
    v_add_f32 v15, v15, v33
    v_cvt_pk_bf16_f32 v15, 0, v15
    v_mul_f32 v15, v15, v32
    v_cvt_f32_i32 v16, v90
    v_cvt_pk_bf16_f32 v16, 0, v16
    v_add_f32 v16, v16, v33
    v_cvt_pk_bf16_f32 v16, 0, v16
    v_mul_f32 v16, v16, v32
    v_cvt_f32_i32 v17, v94
    v_cvt_pk_bf16_f32 v17, 0, v17
    v_add_f32 v17, v17, v33
    v_cvt_pk_bf16_f32 v17, 0, v17
    v_mul_f32 v17, v17, v32
    s_add_u32 s54, s49, 8257536
    buffer_load_dwordx4 v[108:111], v1, s[20:23], s54 offen
    v_cvt_f32_i32 v18, v98
    v_cvt_pk_bf16_f32 v18, 0, v18
    v_add_f32 v18, v18, v33
    v_cvt_pk_bf16_f32 v18, 0, v18
    v_mul_f32 v18, v18, v32
    v_cvt_f32_i32 v19, v102
    v_cvt_pk_bf16_f32 v19, 0, v19
    v_add_f32 v19, v19, v33
    v_cvt_pk_bf16_f32 v19, 0, v19
    v_mul_f32 v19, v19, v32
    v_cvt_pk_bf16_f32 v12, v12, v13
    v_cvt_pk_bf16_f32 v13, v14, v15
    v_cvt_pk_bf16_f32 v14, v16, v17
    v_cvt_pk_bf16_f32 v15, v18, v19
    v_cvt_f32_i32 v20, v75
    s_add_u32 s54, s49, 8275968
    buffer_load_dwordx4 v[112:115], v1, s[20:23], s54 offen
    v_cvt_pk_bf16_f32 v20, 0, v20
    v_add_f32 v20, v20, v35
    v_cvt_pk_bf16_f32 v20, 0, v20
    v_mul_f32 v20, v20, v34
    v_cvt_f32_i32 v21, v79
    v_cvt_pk_bf16_f32 v21, 0, v21
    v_add_f32 v21, v21, v35
    v_cvt_pk_bf16_f32 v21, 0, v21
    v_mul_f32 v21, v21, v34
    ds_write_b128 v3, v[12:15] offset:4096
    v_cvt_f32_i32 v22, v83
    v_cvt_pk_bf16_f32 v22, 0, v22
    v_add_f32 v22, v22, v35
    v_cvt_pk_bf16_f32 v22, 0, v22
    v_mul_f32 v22, v22, v34
    s_add_u32 s54, s49, 8294400
    buffer_load_dwordx4 v[116:119], v1, s[20:23], s54 offen
    v_cvt_f32_i32 v23, v87
    v_cvt_pk_bf16_f32 v23, 0, v23
    v_add_f32 v23, v23, v35
    v_cvt_pk_bf16_f32 v23, 0, v23
    v_mul_f32 v23, v23, v34
    v_cvt_f32_i32 v24, v91
    v_cvt_pk_bf16_f32 v24, 0, v24
    v_add_f32 v24, v24, v35
    v_cvt_pk_bf16_f32 v24, 0, v24
    v_mul_f32 v24, v24, v34
    v_cvt_f32_i32 v25, v95
    v_cvt_pk_bf16_f32 v25, 0, v25
    v_add_f32 v25, v25, v35
    v_cvt_pk_bf16_f32 v25, 0, v25
    v_mul_f32 v25, v25, v34
    s_add_u32 s54, s49, 8312832
    buffer_load_dwordx4 v[120:123], v1, s[20:23], s54 offen
    v_cvt_f32_i32 v26, v99
    v_cvt_pk_bf16_f32 v26, 0, v26
    v_add_f32 v26, v26, v35
    v_cvt_pk_bf16_f32 v26, 0, v26
    v_mul_f32 v26, v26, v34
    v_cvt_f32_i32 v27, v103
    v_cvt_pk_bf16_f32 v27, 0, v27
    v_add_f32 v27, v27, v35
    v_cvt_pk_bf16_f32 v27, 0, v27
    v_mul_f32 v27, v27, v34
    v_cvt_pk_bf16_f32 v20, v20, v21
    v_cvt_pk_bf16_f32 v21, v22, v23
    v_cvt_pk_bf16_f32 v22, v24, v25
    v_cvt_pk_bf16_f32 v23, v26, v27
    v_cvt_f32_i32 v12, v104
    s_add_u32 s54, s49, 8331264
    buffer_load_dwordx4 v[124:127], v1, s[20:23], s54 offen
    v_cvt_pk_bf16_f32 v12, 0, v12
    v_add_f32 v12, v12, v37
    v_cvt_pk_bf16_f32 v12, 0, v12
    v_mul_f32 v12, v12, v36
    v_cvt_f32_i32 v13, v105
    v_cvt_pk_bf16_f32 v13, 0, v13
    v_add_f32 v13, v13, v37
    v_cvt_pk_bf16_f32 v13, 0, v13
    v_mul_f32 v13, v13, v36
    ds_write_b128 v3, v[20:23] offset:6144
    v_cvt_f32_i32 v14, v106
    v_cvt_pk_bf16_f32 v14, 0, v14
    v_add_f32 v14, v14, v37
    v_cvt_pk_bf16_f32 v14, 0, v14
    v_mul_f32 v14, v14, v36
    s_add_u32 s54, s49, 8349696
    buffer_load_dwordx4 v[128:131], v1, s[20:23], s54 offen
    v_cvt_f32_i32 v15, v107
    v_cvt_pk_bf16_f32 v15, 0, v15
    v_add_f32 v15, v15, v37
    v_cvt_pk_bf16_f32 v15, 0, v15
    v_mul_f32 v15, v15, v36
    v_cvt_pk_bf16_f32 v12, v12, v13
    v_cvt_pk_bf16_f32 v13, v14, v15
    ds_write_b64 v4, v[12:13] offset:16384
    ds_read_b128 v[28:31], v5 offset:44928
    ds_read_b128 v[32:35], v5 offset:44944
    ds_read_b64 v[36:37], v6 offset:45952
    s_waitcnt vmcnt(6) lgkmcnt(3)
    s_barrier
    s_add_u32 s54, s49, 8368128
    buffer_load_dwordx4 v[132:135], v1, s[20:23], s54 offen
    s_add_u32 s54, s49, 8386560
    buffer_load_dwordx4 v[136:139], v1, s[20:23], s54 offen
    s_add_u32 s55, s49, 8257536
    buffer_load_dword v140, v2, s[20:23], s55 offen
    s_add_u32 s55, s49, 8275968
    buffer_load_dword v141, v2, s[20:23], s55 offen
    s_add_u32 s55, s49, 8294400
    buffer_load_dword v142, v2, s[20:23], s55 offen
    s_add_u32 s55, s49, 8312832
    buffer_load_dword v143, v2, s[20:23], s55 offen
    s_add_u32 m0, s39, 7296
    s_nop 0
    buffer_load_dwordx4 v7, s[16:19], s40 offen offset:896 lds
    s_waitcnt vmcnt(1) lgkmcnt(0)
    v_cvt_f32_i32 v12, v108
    v_cvt_pk_bf16_f32 v12, 0, v12
    v_add_f32 v12, v12, v29
    v_cvt_pk_bf16_f32 v12, 0, v12
    v_mul_f32 v12, v12, v28
    v_cvt_f32_i32 v13, v112
    v_cvt_pk_bf16_f32 v13, 0, v13
    v_add_f32 v13, v13, v29
    v_cvt_pk_bf16_f32 v13, 0, v13
    v_mul_f32 v13, v13, v28
    v_cvt_f32_i32 v14, v116
    v_cvt_pk_bf16_f32 v14, 0, v14
    v_add_f32 v14, v14, v29
    v_cvt_pk_bf16_f32 v14, 0, v14
    v_mul_f32 v14, v14, v28
    s_add_u32 m0, s39, 8320
    s_nop 0
    buffer_load_dwordx4 v8, s[16:19], s41 offen offset:896 lds
    v_cvt_f32_i32 v15, v120
    v_cvt_pk_bf16_f32 v15, 0, v15
    v_add_f32 v15, v15, v29
    v_cvt_pk_bf16_f32 v15, 0, v15
    v_mul_f32 v15, v15, v28
    v_cvt_f32_i32 v16, v124
    v_cvt_pk_bf16_f32 v16, 0, v16
    v_add_f32 v16, v16, v29
    v_cvt_pk_bf16_f32 v16, 0, v16
    v_mul_f32 v16, v16, v28
    v_cvt_f32_i32 v17, v128
    v_cvt_pk_bf16_f32 v17, 0, v17
    v_add_f32 v17, v17, v29
    v_cvt_pk_bf16_f32 v17, 0, v17
    v_mul_f32 v17, v17, v28
    s_add_u32 m0, s39, 9344
    s_nop 0
    buffer_load_dwordx4 v7, s[16:19], s42 offen offset:896 lds
    v_cvt_f32_i32 v18, v132
    v_cvt_pk_bf16_f32 v18, 0, v18
    v_add_f32 v18, v18, v29
    v_cvt_pk_bf16_f32 v18, 0, v18
    v_mul_f32 v18, v18, v28
    v_cvt_f32_i32 v19, v136
    v_cvt_pk_bf16_f32 v19, 0, v19
    v_add_f32 v19, v19, v29
    v_cvt_pk_bf16_f32 v19, 0, v19
    v_mul_f32 v19, v19, v28
    v_cvt_pk_bf16_f32 v12, v12, v13
    v_cvt_pk_bf16_f32 v13, v14, v15
    v_cvt_pk_bf16_f32 v14, v16, v17
    v_cvt_pk_bf16_f32 v15, v18, v19
    v_cvt_f32_i32 v20, v109
    s_add_u32 m0, s39, 10368
    s_nop 0
    buffer_load_dwordx4 v8, s[16:19], s43 offen offset:896 lds
    v_cvt_pk_bf16_f32 v20, 0, v20
    v_add_f32 v20, v20, v31
    v_cvt_pk_bf16_f32 v20, 0, v20
    v_mul_f32 v20, v20, v30
    v_cvt_f32_i32 v21, v113
    v_cvt_pk_bf16_f32 v21, 0, v21
    v_add_f32 v21, v21, v31
    v_cvt_pk_bf16_f32 v21, 0, v21
    v_mul_f32 v21, v21, v30
    ds_write_b128 v3, v[12:15] offset:18432
    v_cvt_f32_i32 v22, v117
    v_cvt_pk_bf16_f32 v22, 0, v22
    v_add_f32 v22, v22, v31
    v_cvt_pk_bf16_f32 v22, 0, v22
    v_mul_f32 v22, v22, v30
    s_add_u32 m0, s39, 11392
    s_nop 0
    buffer_load_dwordx4 v7, s[16:19], s44 offen offset:896 lds
    v_cvt_f32_i32 v23, v121
    v_cvt_pk_bf16_f32 v23, 0, v23
    v_add_f32 v23, v23, v31
    v_cvt_pk_bf16_f32 v23, 0, v23
    v_mul_f32 v23, v23, v30
    v_cvt_f32_i32 v24, v125
    v_cvt_pk_bf16_f32 v24, 0, v24
    v_add_f32 v24, v24, v31
    v_cvt_pk_bf16_f32 v24, 0, v24
    v_mul_f32 v24, v24, v30
    v_cvt_f32_i32 v25, v129
    v_cvt_pk_bf16_f32 v25, 0, v25
    v_add_f32 v25, v25, v31
    v_cvt_pk_bf16_f32 v25, 0, v25
    v_mul_f32 v25, v25, v30
    s_add_u32 m0, s39, 12416
    s_nop 0
    buffer_load_dwordx4 v8, s[16:19], s45 offen offset:896 lds
    v_cvt_f32_i32 v26, v133
    v_cvt_pk_bf16_f32 v26, 0, v26
    v_add_f32 v26, v26, v31
    v_cvt_pk_bf16_f32 v26, 0, v26
    v_mul_f32 v26, v26, v30
    v_cvt_f32_i32 v27, v137
    v_cvt_pk_bf16_f32 v27, 0, v27
    v_add_f32 v27, v27, v31
    v_cvt_pk_bf16_f32 v27, 0, v27
    v_mul_f32 v27, v27, v30
    v_cvt_pk_bf16_f32 v20, v20, v21
    v_cvt_pk_bf16_f32 v21, v22, v23
    v_cvt_pk_bf16_f32 v22, v24, v25
    v_cvt_pk_bf16_f32 v23, v26, v27
    v_cvt_f32_i32 v12, v110
    s_add_u32 m0, s39, 13440
    s_nop 0
    buffer_load_dwordx4 v7, s[16:19], s46 offen offset:896 lds
    v_cvt_pk_bf16_f32 v12, 0, v12
    v_add_f32 v12, v12, v33
    v_cvt_pk_bf16_f32 v12, 0, v12
    v_mul_f32 v12, v12, v32
    v_cvt_f32_i32 v13, v114
    v_cvt_pk_bf16_f32 v13, 0, v13
    v_add_f32 v13, v13, v33
    v_cvt_pk_bf16_f32 v13, 0, v13
    v_mul_f32 v13, v13, v32
    ds_write_b128 v3, v[20:23] offset:20480
    v_cvt_f32_i32 v14, v118
    v_cvt_pk_bf16_f32 v14, 0, v14
    v_add_f32 v14, v14, v33
    v_cvt_pk_bf16_f32 v14, 0, v14
    v_mul_f32 v14, v14, v32
    s_add_u32 m0, s39, 14464
    s_nop 0
    buffer_load_dwordx4 v8, s[16:19], s47 offen offset:896 lds
    v_cvt_f32_i32 v15, v122
    v_cvt_pk_bf16_f32 v15, 0, v15
    v_add_f32 v15, v15, v33
    v_cvt_pk_bf16_f32 v15, 0, v15
    v_mul_f32 v15, v15, v32
    v_cvt_f32_i32 v16, v126
    v_cvt_pk_bf16_f32 v16, 0, v16
    v_add_f32 v16, v16, v33
    v_cvt_pk_bf16_f32 v16, 0, v16
    v_mul_f32 v16, v16, v32
    v_cvt_f32_i32 v17, v130
    v_cvt_pk_bf16_f32 v17, 0, v17
    v_add_f32 v17, v17, v33
    v_cvt_pk_bf16_f32 v17, 0, v17
    v_mul_f32 v17, v17, v32
    s_add_u32 s54, s49, 9437184
    buffer_load_dwordx4 v[144:147], v1, s[20:23], s54 offen
    v_cvt_f32_i32 v18, v134
    v_cvt_pk_bf16_f32 v18, 0, v18
    v_add_f32 v18, v18, v33
    v_cvt_pk_bf16_f32 v18, 0, v18
    v_mul_f32 v18, v18, v32
    v_cvt_f32_i32 v19, v138
    v_cvt_pk_bf16_f32 v19, 0, v19
    v_add_f32 v19, v19, v33
    v_cvt_pk_bf16_f32 v19, 0, v19
    v_mul_f32 v19, v19, v32
    v_cvt_pk_bf16_f32 v12, v12, v13
    v_cvt_pk_bf16_f32 v13, v14, v15
    v_cvt_pk_bf16_f32 v14, v16, v17
    v_cvt_pk_bf16_f32 v15, v18, v19
    v_cvt_f32_i32 v20, v111
    s_add_u32 s54, s49, 9455616
    buffer_load_dwordx4 v[148:151], v1, s[20:23], s54 offen
    v_cvt_pk_bf16_f32 v20, 0, v20
    v_add_f32 v20, v20, v35
    v_cvt_pk_bf16_f32 v20, 0, v20
    v_mul_f32 v20, v20, v34
    v_cvt_f32_i32 v21, v115
    v_cvt_pk_bf16_f32 v21, 0, v21
    v_add_f32 v21, v21, v35
    v_cvt_pk_bf16_f32 v21, 0, v21
    v_mul_f32 v21, v21, v34
    ds_write_b128 v3, v[12:15] offset:22528
    v_cvt_f32_i32 v22, v119
    v_cvt_pk_bf16_f32 v22, 0, v22
    v_add_f32 v22, v22, v35
    v_cvt_pk_bf16_f32 v22, 0, v22
    v_mul_f32 v22, v22, v34
    s_add_u32 s54, s49, 9474048
    buffer_load_dwordx4 v[152:155], v1, s[20:23], s54 offen
    v_cvt_f32_i32 v23, v123
    v_cvt_pk_bf16_f32 v23, 0, v23
    v_add_f32 v23, v23, v35
    v_cvt_pk_bf16_f32 v23, 0, v23
    v_mul_f32 v23, v23, v34
    v_cvt_f32_i32 v24, v127
    v_cvt_pk_bf16_f32 v24, 0, v24
    v_add_f32 v24, v24, v35
    v_cvt_pk_bf16_f32 v24, 0, v24
    v_mul_f32 v24, v24, v34
    v_cvt_f32_i32 v25, v131
    v_cvt_pk_bf16_f32 v25, 0, v25
    v_add_f32 v25, v25, v35
    v_cvt_pk_bf16_f32 v25, 0, v25
    v_mul_f32 v25, v25, v34
    s_add_u32 s54, s49, 9492480
    buffer_load_dwordx4 v[156:159], v1, s[20:23], s54 offen
    v_cvt_f32_i32 v26, v135
    v_cvt_pk_bf16_f32 v26, 0, v26
    v_add_f32 v26, v26, v35
    v_cvt_pk_bf16_f32 v26, 0, v26
    v_mul_f32 v26, v26, v34
    v_cvt_f32_i32 v27, v139
    v_cvt_pk_bf16_f32 v27, 0, v27
    v_add_f32 v27, v27, v35
    v_cvt_pk_bf16_f32 v27, 0, v27
    v_mul_f32 v27, v27, v34
    v_cvt_pk_bf16_f32 v20, v20, v21
    v_cvt_pk_bf16_f32 v21, v22, v23
    v_cvt_pk_bf16_f32 v22, v24, v25
    v_cvt_pk_bf16_f32 v23, v26, v27
    v_cvt_f32_i32 v12, v140
    s_add_u32 s54, s49, 9510912
    buffer_load_dwordx4 v[160:163], v1, s[20:23], s54 offen
    v_cvt_pk_bf16_f32 v12, 0, v12
    v_add_f32 v12, v12, v37
    v_cvt_pk_bf16_f32 v12, 0, v12
    v_mul_f32 v12, v12, v36
    v_cvt_f32_i32 v13, v141
    v_cvt_pk_bf16_f32 v13, 0, v13
    v_add_f32 v13, v13, v37
    v_cvt_pk_bf16_f32 v13, 0, v13
    v_mul_f32 v13, v13, v36
    ds_write_b128 v3, v[20:23] offset:24576
    v_cvt_f32_i32 v14, v142
    v_cvt_pk_bf16_f32 v14, 0, v14
    v_add_f32 v14, v14, v37
    v_cvt_pk_bf16_f32 v14, 0, v14
    v_mul_f32 v14, v14, v36
    s_add_u32 s54, s49, 9529344
    buffer_load_dwordx4 v[164:167], v1, s[20:23], s54 offen
    v_cvt_f32_i32 v15, v143
    v_cvt_pk_bf16_f32 v15, 0, v15
    v_add_f32 v15, v15, v37
    v_cvt_pk_bf16_f32 v15, 0, v15
    v_mul_f32 v15, v15, v36
    v_cvt_pk_bf16_f32 v12, v12, v13
    v_cvt_pk_bf16_f32 v13, v14, v15
    ds_write_b64 v4, v[12:13] offset:34816
    ds_read_b128 v[28:31], v5 offset:46080
    ds_read_b128 v[32:35], v5 offset:46096
    ds_read_b64 v[36:37], v6 offset:47104
    s_waitcnt vmcnt(6) lgkmcnt(3)
    s_barrier
    s_add_u32 s54, s49, 9547776
    buffer_load_dwordx4 v[168:171], v1, s[20:23], s54 offen
    s_add_u32 s54, s49, 9566208
    buffer_load_dwordx4 v[172:175], v1, s[20:23], s54 offen
    s_add_u32 s55, s49, 9437184
    buffer_load_dword v176, v2, s[20:23], s55 offen
    s_add_u32 s55, s49, 9455616
    buffer_load_dword v177, v2, s[20:23], s55 offen
    s_add_u32 s55, s49, 9474048
    buffer_load_dword v178, v2, s[20:23], s55 offen
    s_add_u32 s55, s49, 9492480
    buffer_load_dword v179, v2, s[20:23], s55 offen
    s_add_u32 m0, s39, 15360
    s_nop 0
    buffer_load_dwordx4 v7, s[16:19], s40 offen offset:1024 lds
    s_waitcnt vmcnt(1) lgkmcnt(0)
    v_cvt_f32_i32 v12, v144
    v_cvt_pk_bf16_f32 v12, 0, v12
    v_add_f32 v12, v12, v29
    v_cvt_pk_bf16_f32 v12, 0, v12
    v_mul_f32 v12, v12, v28
    v_cvt_f32_i32 v13, v148
    v_cvt_pk_bf16_f32 v13, 0, v13
    v_add_f32 v13, v13, v29
    v_cvt_pk_bf16_f32 v13, 0, v13
    v_mul_f32 v13, v13, v28
    v_cvt_f32_i32 v14, v152
    v_cvt_pk_bf16_f32 v14, 0, v14
    v_add_f32 v14, v14, v29
    v_cvt_pk_bf16_f32 v14, 0, v14
    v_mul_f32 v14, v14, v28
    s_add_u32 m0, s39, 16384
    s_nop 0
    buffer_load_dwordx4 v8, s[16:19], s41 offen offset:1024 lds
    v_cvt_f32_i32 v15, v156
    v_cvt_pk_bf16_f32 v15, 0, v15
    v_add_f32 v15, v15, v29
    v_cvt_pk_bf16_f32 v15, 0, v15
    v_mul_f32 v15, v15, v28
    v_cvt_f32_i32 v16, v160
    v_cvt_pk_bf16_f32 v16, 0, v16
    v_add_f32 v16, v16, v29
    v_cvt_pk_bf16_f32 v16, 0, v16
    v_mul_f32 v16, v16, v28
    v_cvt_f32_i32 v17, v164
    v_cvt_pk_bf16_f32 v17, 0, v17
    v_add_f32 v17, v17, v29
    v_cvt_pk_bf16_f32 v17, 0, v17
    v_mul_f32 v17, v17, v28
    s_add_u32 m0, s39, 17408
    s_nop 0
    buffer_load_dwordx4 v7, s[16:19], s42 offen offset:1024 lds
    v_cvt_f32_i32 v18, v168
    v_cvt_pk_bf16_f32 v18, 0, v18
    v_add_f32 v18, v18, v29
    v_cvt_pk_bf16_f32 v18, 0, v18
    v_mul_f32 v18, v18, v28
    v_cvt_f32_i32 v19, v172
    v_cvt_pk_bf16_f32 v19, 0, v19
    v_add_f32 v19, v19, v29
    v_cvt_pk_bf16_f32 v19, 0, v19
    v_mul_f32 v19, v19, v28
    v_cvt_pk_bf16_f32 v12, v12, v13
    v_cvt_pk_bf16_f32 v13, v14, v15
    v_cvt_pk_bf16_f32 v14, v16, v17
    v_cvt_pk_bf16_f32 v15, v18, v19
    v_cvt_f32_i32 v20, v145
    s_add_u32 m0, s39, 18432
    s_nop 0
    buffer_load_dwordx4 v8, s[16:19], s43 offen offset:1024 lds
    v_cvt_pk_bf16_f32 v20, 0, v20
    v_add_f32 v20, v20, v31
    v_cvt_pk_bf16_f32 v20, 0, v20
    v_mul_f32 v20, v20, v30
    v_cvt_f32_i32 v21, v149
    v_cvt_pk_bf16_f32 v21, 0, v21
    v_add_f32 v21, v21, v31
    v_cvt_pk_bf16_f32 v21, 0, v21
    v_mul_f32 v21, v21, v30
    ds_write_b128 v3, v[12:15] offset:0
    v_cvt_f32_i32 v22, v153
    v_cvt_pk_bf16_f32 v22, 0, v22
    v_add_f32 v22, v22, v31
    v_cvt_pk_bf16_f32 v22, 0, v22
    v_mul_f32 v22, v22, v30
    s_add_u32 m0, s39, 19456
    s_nop 0
    buffer_load_dwordx4 v7, s[16:19], s44 offen offset:1024 lds
    v_cvt_f32_i32 v23, v157
    v_cvt_pk_bf16_f32 v23, 0, v23
    v_add_f32 v23, v23, v31
    v_cvt_pk_bf16_f32 v23, 0, v23
    v_mul_f32 v23, v23, v30
    v_cvt_f32_i32 v24, v161
    v_cvt_pk_bf16_f32 v24, 0, v24
    v_add_f32 v24, v24, v31
    v_cvt_pk_bf16_f32 v24, 0, v24
    v_mul_f32 v24, v24, v30
    v_cvt_f32_i32 v25, v165
    v_cvt_pk_bf16_f32 v25, 0, v25
    v_add_f32 v25, v25, v31
    v_cvt_pk_bf16_f32 v25, 0, v25
    v_mul_f32 v25, v25, v30
    s_add_u32 m0, s39, 20480
    s_nop 0
    buffer_load_dwordx4 v8, s[16:19], s45 offen offset:1024 lds
    v_cvt_f32_i32 v26, v169
    v_cvt_pk_bf16_f32 v26, 0, v26
    v_add_f32 v26, v26, v31
    v_cvt_pk_bf16_f32 v26, 0, v26
    v_mul_f32 v26, v26, v30
    v_cvt_f32_i32 v27, v173
    v_cvt_pk_bf16_f32 v27, 0, v27
    v_add_f32 v27, v27, v31
    v_cvt_pk_bf16_f32 v27, 0, v27
    v_mul_f32 v27, v27, v30
    v_cvt_pk_bf16_f32 v20, v20, v21
    v_cvt_pk_bf16_f32 v21, v22, v23
    v_cvt_pk_bf16_f32 v22, v24, v25
    v_cvt_pk_bf16_f32 v23, v26, v27
    v_cvt_f32_i32 v12, v146
    s_add_u32 m0, s39, 21504
    s_nop 0
    buffer_load_dwordx4 v7, s[16:19], s46 offen offset:1024 lds
    v_cvt_pk_bf16_f32 v12, 0, v12
    v_add_f32 v12, v12, v33
    v_cvt_pk_bf16_f32 v12, 0, v12
    v_mul_f32 v12, v12, v32
    v_cvt_f32_i32 v13, v150
    v_cvt_pk_bf16_f32 v13, 0, v13
    v_add_f32 v13, v13, v33
    v_cvt_pk_bf16_f32 v13, 0, v13
    v_mul_f32 v13, v13, v32
    ds_write_b128 v3, v[20:23] offset:2048
    v_cvt_f32_i32 v14, v154
    v_cvt_pk_bf16_f32 v14, 0, v14
    v_add_f32 v14, v14, v33
    v_cvt_pk_bf16_f32 v14, 0, v14
    v_mul_f32 v14, v14, v32
    s_add_u32 m0, s39, 22528
    s_nop 0
    buffer_load_dwordx4 v8, s[16:19], s47 offen offset:1024 lds
    v_cvt_f32_i32 v15, v158
    v_cvt_pk_bf16_f32 v15, 0, v15
    v_add_f32 v15, v15, v33
    v_cvt_pk_bf16_f32 v15, 0, v15
    v_mul_f32 v15, v15, v32
    v_cvt_f32_i32 v16, v162
    v_cvt_pk_bf16_f32 v16, 0, v16
    v_add_f32 v16, v16, v33
    v_cvt_pk_bf16_f32 v16, 0, v16
    v_mul_f32 v16, v16, v32
    v_cvt_f32_i32 v17, v166
    v_cvt_pk_bf16_f32 v17, 0, v17
    v_add_f32 v17, v17, v33
    v_cvt_pk_bf16_f32 v17, 0, v17
    v_mul_f32 v17, v17, v32
    v_cvt_f32_i32 v18, v170
    v_cvt_pk_bf16_f32 v18, 0, v18
    v_add_f32 v18, v18, v33
    v_cvt_pk_bf16_f32 v18, 0, v18
    v_mul_f32 v18, v18, v32
    v_cvt_f32_i32 v19, v174
    v_cvt_pk_bf16_f32 v19, 0, v19
    v_add_f32 v19, v19, v33
    v_cvt_pk_bf16_f32 v19, 0, v19
    v_mul_f32 v19, v19, v32
    v_cvt_pk_bf16_f32 v12, v12, v13
    v_cvt_pk_bf16_f32 v13, v14, v15
    v_cvt_pk_bf16_f32 v14, v16, v17
    v_cvt_pk_bf16_f32 v15, v18, v19
    v_cvt_f32_i32 v20, v147
    v_cvt_pk_bf16_f32 v20, 0, v20
    v_add_f32 v20, v20, v35
    v_cvt_pk_bf16_f32 v20, 0, v20
    v_mul_f32 v20, v20, v34
    v_cvt_f32_i32 v21, v151
    v_cvt_pk_bf16_f32 v21, 0, v21
    v_add_f32 v21, v21, v35
    v_cvt_pk_bf16_f32 v21, 0, v21
    v_mul_f32 v21, v21, v34
    ds_write_b128 v3, v[12:15] offset:4096
    v_cvt_f32_i32 v22, v155
    v_cvt_pk_bf16_f32 v22, 0, v22
    v_add_f32 v22, v22, v35
    v_cvt_pk_bf16_f32 v22, 0, v22
    v_mul_f32 v22, v22, v34
    v_cvt_f32_i32 v23, v159
    v_cvt_pk_bf16_f32 v23, 0, v23
    v_add_f32 v23, v23, v35
    v_cvt_pk_bf16_f32 v23, 0, v23
    v_mul_f32 v23, v23, v34
    v_cvt_f32_i32 v24, v163
    v_cvt_pk_bf16_f32 v24, 0, v24
    v_add_f32 v24, v24, v35
    v_cvt_pk_bf16_f32 v24, 0, v24
    v_mul_f32 v24, v24, v34
    v_cvt_f32_i32 v25, v167
    v_cvt_pk_bf16_f32 v25, 0, v25
    v_add_f32 v25, v25, v35
    v_cvt_pk_bf16_f32 v25, 0, v25
    v_mul_f32 v25, v25, v34
    v_cvt_f32_i32 v26, v171
    v_cvt_pk_bf16_f32 v26, 0, v26
    v_add_f32 v26, v26, v35
    v_cvt_pk_bf16_f32 v26, 0, v26
    v_mul_f32 v26, v26, v34
    v_cvt_f32_i32 v27, v175
    v_cvt_pk_bf16_f32 v27, 0, v27
    v_add_f32 v27, v27, v35
    v_cvt_pk_bf16_f32 v27, 0, v27
    v_mul_f32 v27, v27, v34
    v_cvt_pk_bf16_f32 v20, v20, v21
    v_cvt_pk_bf16_f32 v21, v22, v23
    v_cvt_pk_bf16_f32 v22, v24, v25
    v_cvt_pk_bf16_f32 v23, v26, v27
    v_cvt_f32_i32 v12, v176
    v_cvt_pk_bf16_f32 v12, 0, v12
    v_add_f32 v12, v12, v37
    v_cvt_pk_bf16_f32 v12, 0, v12
    v_mul_f32 v12, v12, v36
    v_cvt_f32_i32 v13, v177
    v_cvt_pk_bf16_f32 v13, 0, v13
    v_add_f32 v13, v13, v37
    v_cvt_pk_bf16_f32 v13, 0, v13
    v_mul_f32 v13, v13, v36
    ds_write_b128 v3, v[20:23] offset:6144
    v_cvt_f32_i32 v14, v178
    v_cvt_pk_bf16_f32 v14, 0, v14
    v_add_f32 v14, v14, v37
    v_cvt_pk_bf16_f32 v14, 0, v14
    v_mul_f32 v14, v14, v36
    v_cvt_f32_i32 v15, v179
    v_cvt_pk_bf16_f32 v15, 0, v15
    v_add_f32 v15, v15, v37
    v_cvt_pk_bf16_f32 v15, 0, v15
    v_mul_f32 v15, v15, v36
    v_cvt_pk_bf16_f32 v12, v12, v13
    v_cvt_pk_bf16_f32 v13, v14, v15
    ds_write_b64 v4, v[12:13] offset:16384
    s_waitcnt vmcnt(0) lgkmcnt(0)
    s_barrier
    s_endpgm
L_end:
    s_endpgm
.section .rodata,"a"
.p2align 6
.amdhsa_kernel standalone__weight_only_int_quip_2__prompt_kernel
  .amdhsa_next_free_vgpr 256
  .amdhsa_next_free_sgpr 102
  .amdhsa_accum_offset 200
  .amdhsa_group_segment_fixed_size 0
  .amdhsa_kernarg_size 56
  .amdhsa_user_sgpr_count 2
  .amdhsa_user_sgpr_kernarg_segment_ptr 1
  .amdhsa_system_sgpr_workgroup_id_x 1
  .amdhsa_float_denorm_mode_32 3
  .amdhsa_float_denorm_mode_16_64 3
.end_amdhsa_kernel
```
